```python
import torch

def _softmax(x, axis=-1):
    return torch.softmax(x, dim=axis)
def _gelu(x):
    return torch.nn.functional.gelu(x, approximate="tanh")
def _silu(x):
    return torch.nn.functional.silu(x)
def _sigmoid(x):
    return torch.sigmoid(x)
def _layernorm(x, axis=-1, eps=1e-5):
    m = x.mean(dim=axis, keepdim=True)
    v = x.var(dim=axis, keepdim=True, unbiased=False)
    return (x - m) / torch.sqrt(v + eps)
def _scatter_add(tgt, idx, src, axis=0):
    return tgt.clone().index_add_(axis, idx, src)
def _segment_sum(src, seg, n):
    out = torch.zeros((n,) + src.shape[1:], dtype=src.dtype)
    return out.index_add_(0, seg, src)
def _pad(x, pw):
    flat = tuple(v for pair in reversed(pw) for v in pair)
    return torch.nn.functional.pad(x, flat)

kernel_name = 'recurrent_scan__compressed_kv_cla__dense_activation_squared_relu__decode'

def setup_inputs():

    _w = (lambda a: (lambda t: t.to(torch.bfloat16) if t.is_floating_point() else t)(torch.as_tensor(a)))
    def _A_setup():
        B, H, Sq, Sk, D, M = 1, 32, 1, 4096, 128, 640
        Dc = 4 * D
        return {
            "x": _w((lambda *s: torch.randn(*s, dtype=torch.bfloat16) * 0.05)(B, Sq, M)),
            "c_kv": _w((lambda *s: torch.randn(*s, dtype=torch.bfloat16) * 0.2)(B, Sk, Dc)),
            "w_q": _w((lambda *s: torch.randn(*s, dtype=torch.bfloat16) * 3.2)(M, H, D) * (M ** -0.5)),
            "w_uk": _w((lambda *s: torch.randn(*s, dtype=torch.bfloat16) * 3.2)(Dc, H, D) * (Dc ** -0.5)),
            "w_uv": _w((lambda *s: torch.randn(*s, dtype=torch.bfloat16) * 0.2)(Dc, H, D) * (Dc ** -0.5)),
            "w_o": _w((lambda *s: torch.randn(*s, dtype=torch.bfloat16) * 0.2)(H, D, M) * ((H * D) ** -0.5)),
        }
    _A_in = _A_setup()

    def _B_setup():
        B, S, D, F = 1, 1, 640, 1728
        return {
            "x": _w((lambda *s: torch.randn(*s, dtype=torch.bfloat16) * 0.05)(B, S, D)),
            "w1": _w((lambda *s: torch.randn(*s, dtype=torch.bfloat16) * 0.1)(D, F)),
            "b1": _w((lambda *s: torch.randn(*s, dtype=torch.bfloat16) * 0.8)(F)),
            "w2": _w((lambda *s: torch.randn(*s, dtype=torch.bfloat16) * 0.1)(F, D)),
            "b2": _w((lambda *s: torch.randn(*s, dtype=torch.bfloat16) * 12.8)(D)),
        }
    _B_in = _B_setup()

    return {
        "A_x": _A_in["x"],
        "A_c_kv": _A_in["c_kv"],
        "A_w_q": _A_in["w_q"],
        "A_w_uk": _A_in["w_uk"],
        "A_w_uv": _A_in["w_uv"],
        "A_w_o": _A_in["w_o"],
        "B_x": _B_in["x"],
        "B_w1": _B_in["w1"],
        "B_b1": _B_in["b1"],
        "B_w2": _B_in["w2"],
        "B_b2": _B_in["b2"],
    }

def reference(A_x, A_c_kv, A_w_q, A_w_uk, A_w_uv, A_w_o, B_x, B_w1, B_b1, B_w2, B_b2):
    def _A_ref(x, c_kv, w_q, w_uk, w_uv, w_o):
        B, Sq, M = x.shape[0], x.shape[1], x.shape[2]
        Sk = c_kv.shape[1]
        H, D = w_q.shape[1], w_q.shape[2]
        q = torch.einsum("bqm,mhd->bhqd", x, w_q)
        k = torch.einsum("bkc,chd->bhkd", c_kv, w_uk)
        v = torch.einsum("bkc,chd->bhkd", c_kv, w_uv)
        scores = torch.einsum("bhqd,bhkd->bhqk", q, k) * (D ** -0.5)
        off = Sk - Sq
        qi = torch.arange(Sq)[:, None]
        kj = torch.arange(Sk)[None, :]
        cmask = kj <= (qi + off)
        scores = torch.where(cmask[None, None], scores, -1e9)
        p = _softmax(scores, axis=-1)
        ctx = torch.einsum("bhqk,bhkd->bhqd", p, v)
        return torch.einsum("bhqd,hdm->bqm", ctx, w_o)

    def _B_ref(x, w1, b1, w2, b2):
        h = torch.einsum("bsd,df->bsf", x, w1) + b1
        zero = torch.zeros_like(h)
        r = torch.where(h > zero, h, zero)
        h = r * r
        out = torch.einsum("bsf,fd->bsd", h, w2) + b2
        return out

    x = A_x
    xn = _layernorm(x, axis=-1)
    s = _A_ref(xn, A_c_kv, A_w_q, A_w_uk, A_w_uv, A_w_o)
    g = _silu(_B_ref(xn, B_w1, B_b1, B_w2, B_b2))
    return x + s * g
```

```asm
; @launch grid=(256,1,1) block=(512,1,1) lds=131072
.amdgcn_target "amdgcn-amd-amdhsa--gfx950"
.text
.globl recurrent_scan__compressed_kv_cla__dense_activation_squared_relu__decode_kernel
.p2align 12
.fill 832, 4, 0xbf800000
.p2align 8
.type recurrent_scan__compressed_kv_cla__dense_activation_squared_relu__decode_kernel,@function
recurrent_scan__compressed_kv_cla__dense_activation_squared_relu__decode_kernel:
KSTART:
    s_cmp_ge_u32 s2, 256
    s_cbranch_scc1 LEND
    s_load_dwordx16 s[4:19], s[0:1], 0
    s_load_dwordx4 s[28:31], s[0:1], 96
    s_load_dwordx8 s[20:27], s[0:1], 64
    v_lshrrev_b32 v8, 6, v0
    v_and_b32 v1, 63, v0
    v_readfirstlane_b32 s44, v8
    s_and_b32 s47, s2, 7
    s_lshr_b32 s48, s2, 3
    s_and_b32 s45, s48, 3
    s_lshl2_add_u32 s45, s47, s45
    s_bfe_u32 s46, s48, 0x20002
    s_add_u32 s3, s45, 32
    s_and_b32 s3, s3, 31
    s_cmp_lg_u32 s44, 7
    s_cbranch_scc1 Lpf_1
    s_getpc_b64 s[56:57]
LPC:
    v_lshlrev_b32 v8, 7, v1
    v_add_u32 v8, KSTART+4096-LPC, v8
    v_min_u32 v8, KEND-LPC-4, v8
    global_load_dword v63, v8, s[56:57]
Lpf_1:
    v_lshrrev_b32 v2, 4, v1
    v_and_b32 v3, 15, v1
    s_and_b32 s53, s44, 1
    s_lshl_b32 s53, s53, 3
    v_lshl_add_u32 v8, v2, 1, s53
    v_xor_b32 v8, v8, v3
    v_lshlrev_b32 v9, 13, v2
    v_lshl_add_u32 v7, v8, 4, v9
    v_lshlrev_b32 v11, 2, v1
    s_movk_i32 s53, 160
    s_cmp_ge_u32 s48, 16
    s_cselect_b32 s53, 128, s53
    s_mul_i32 s53, s53, s46
    s_lshl2_add_u32 s53, s44, s53
    s_lshl_b32 s53, s53, 13
    s_lshl_b32 s58, s45, 8
    s_add_u32 s50, s53, s58
    s_lshl_b32 s51, s44, 10
    s_mov_b32 s35, 0x20000
    s_mov_b32 s42, 1280
    s_mov_b32 s43, 0x20000
    s_mov_b32 s38, 4915200
    s_mov_b32 s39, 0x20000
    s_mov_b32 s53, 296960
    v_lshlrev_b32 v8, 4, v3
    v_mad_u32_u24 v60, v2, s53, v8
    s_cmp_ge_u32 s48, 16
    s_waitcnt lgkmcnt(0)
    s_mov_b32 s40, s4
    s_mov_b32 s41, s5
    s_mov_b32 s36, s30
    s_mov_b32 s37, s31
    s_cbranch_scc1 LC_EARLY
    s_mov_b32 s32, s8
    s_mov_b32 s33, s9
    s_mov_b32 s34, 5242880
    s_cmp_lg_u32 s44, 0
    s_cbranch_scc1 Lnox_2
    buffer_load_dword v12, v11, s[40:43], 0 offen offset:0
    buffer_load_dword v13, v11, s[40:43], 0 offen offset:256
    buffer_load_dword v14, v11, s[40:43], 0 offen offset:512
    buffer_load_dword v15, v11, s[40:43], 0 offen offset:768
    buffer_load_dword v16, v11, s[40:43], 0 offen offset:1024
Lnox_2:
    s_mov_b32 m0, s51
    s_add_u32 s51, s51, 8192
    buffer_load_dwordx4 v7, s[32:35], s50 offen nt lds
    s_add_u32 s50, s50, 262144
    s_mov_b32 m0, s51
    s_add_u32 s51, s51, 8192
    buffer_load_dwordx4 v7, s[32:35], s50 offen nt lds
    s_add_u32 s50, s50, 262144
    s_mov_b32 m0, s51
    s_add_u32 s51, s51, 8192
    buffer_load_dwordx4 v7, s[32:35], s50 offen nt lds
    s_add_u32 s50, s50, 262144
    s_mov_b32 m0, s51
    s_add_u32 s51, s51, 8192
    buffer_load_dwordx4 v7, s[32:35], s50 offen nt lds
    s_add_u32 s50, s50, 262144
    s_mov_b32 m0, s51
    s_nop 0
    buffer_load_dwordx4 v7, s[32:35], s50 offen nt lds
    s_branch LCOMMON
LC_EARLY:
    s_cmp_lg_u32 s44, 0
    s_cbranch_scc1 Lnox_3
    buffer_load_dword v12, v11, s[40:43], 0 offen offset:0
    buffer_load_dword v13, v11, s[40:43], 0 offen offset:256
    buffer_load_dword v14, v11, s[40:43], 0 offen offset:512
    buffer_load_dword v15, v11, s[40:43], 0 offen offset:768
    buffer_load_dword v16, v11, s[40:43], 0 offen offset:1024
Lnox_3:
    s_mov_b32 s32, s10
    s_mov_b32 s33, s11
    s_mov_b32 s34, 4194304
    s_cmp_lg_u32 s44, 1
    s_cbranch_scc1 Lnpt_4
    v_lshlrev_b32 v8, 17, v2
    v_lshl_add_u32 v8, v3, 7, v8
    s_lshl_b32 s53, s45, 11
    s_add_u32 s53, s53, 131072
    s_mov_b32 exec_hi, 0xffff
    buffer_load_dword v63, v8, s[36:39], s53 offen
    s_mov_b32 exec_hi, -1
Lnpt_4:
    s_mov_b32 m0, s51
    s_add_u32 s51, s51, 8192
    buffer_load_dwordx4 v7, s[32:35], s50 offen nt lds
    s_add_u32 s50, s50, 262144
    s_mov_b32 m0, s51
    s_add_u32 s51, s51, 8192
    buffer_load_dwordx4 v7, s[32:35], s50 offen nt lds
    s_add_u32 s50, s50, 262144
    s_mov_b32 m0, s51
    s_add_u32 s51, s51, 8192
    buffer_load_dwordx4 v7, s[32:35], s50 offen nt lds
    s_add_u32 s50, s50, 262144
    s_mov_b32 m0, s51
    s_nop 0
    buffer_load_dwordx4 v7, s[32:35], s50 offen nt lds
    s_mul_i32 s97, s44, 37120
    s_mul_i32 s53, s45, 1152
    s_add_u32 s97, s97, s53
    s_add_u32 s97, s97, 2097152
    s_lshl_b32 s53, s46, 8
    s_add_u32 s62, s97, s53
    s_add_u32 s63, s62, 1187840
    v_mov_b32 v44, -1
    v_mov_b32 v45, -1
    v_mov_b32 v46, -1
    v_mov_b32 v47, -1
    buffer_store_dwordx4 v[44:47], v60, s[36:39], s62 offen sc1
    buffer_store_dwordx4 v[44:47], v60, s[36:39], s63 offen sc1
LCOMMON:
    s_load_dword s49, s[30:31], 0
    v_bfe_u32 v4, v1, 2, 2
    v_and_b32 v5, 3, v1
    s_mov_b32 s59, 0x0c0c0400
    s_mov_b32 s60, 0x05040100
    s_mov_b32 s61, 0x07060302
    s_mov_b32 s96, 0xffffff00
    v_add_u32 v61, 0x07060500, v5
    v_and_b32 v8, 1, v1
    v_mul_u32_u24 v8, 0x202, v8
    v_add_u32 v62, 0x07060100, v8
    s_cmp_lg_u32 s44, 0
    s_cbranch_scc1 Lnoln_6
    s_waitcnt vmcnt(5)
    v_lshlrev_b32 v20, 16, v12
    v_and_b32 v21, 0xffff0000, v12
    v_lshlrev_b32 v22, 16, v13
    v_and_b32 v23, 0xffff0000, v13
    v_lshlrev_b32 v24, 16, v14
    v_and_b32 v25, 0xffff0000, v14
    v_lshlrev_b32 v26, 16, v15
    v_and_b32 v27, 0xffff0000, v15
    v_lshlrev_b32 v28, 16, v16
    v_and_b32 v29, 0xffff0000, v16
    v_add_f32 v8, v20, v21
    v_add_f32 v8, v8, v22
    v_add_f32 v8, v8, v23
    v_add_f32 v8, v8, v24
    v_add_f32 v8, v8, v25
    v_add_f32 v8, v8, v26
    v_add_f32 v8, v8, v27
    v_add_f32 v8, v8, v28
    v_add_f32 v8, v8, v29
    s_nop 1
    v_add_f32_dpp v8, v8, v8 quad_perm:[1,0,3,2] row_mask:0xf bank_mask:0xf
    s_nop 1
    v_add_f32_dpp v8, v8, v8 quad_perm:[2,3,0,1] row_mask:0xf bank_mask:0xf
    s_nop 1
    v_add_f32_dpp v8, v8, v8 row_half_mirror row_mask:0xf bank_mask:0xf
    s_nop 1
    v_add_f32_dpp v8, v8, v8 row_mirror row_mask:0xf bank_mask:0xf
    v_mov_b32 v9, v8
    s_nop 1
    v_permlane32_swap_b32 v8, v9
    v_add_f32 v8, v8, v9
    v_mov_b32 v9, v8
    s_nop 1
    v_permlane16_swap_b32 v8, v9
    v_add_f32 v8, v8, v9
    v_mul_f32 v8, 0x3acccccd, v8
    v_sub_f32 v10, v20, v8
    v_mul_f32 v9, v10, v10
    v_sub_f32 v10, v21, v8
    v_fmac_f32 v9, v10, v10
    v_sub_f32 v10, v22, v8
    v_fmac_f32 v9, v10, v10
    v_sub_f32 v10, v23, v8
    v_fmac_f32 v9, v10, v10
    v_sub_f32 v10, v24, v8
    v_fmac_f32 v9, v10, v10
    v_sub_f32 v10, v25, v8
    v_fmac_f32 v9, v10, v10
    v_sub_f32 v10, v26, v8
    v_fmac_f32 v9, v10, v10
    v_sub_f32 v10, v27, v8
    v_fmac_f32 v9, v10, v10
    v_sub_f32 v10, v28, v8
    v_fmac_f32 v9, v10, v10
    v_sub_f32 v10, v29, v8
    v_fmac_f32 v9, v10, v10
    s_nop 1
    v_add_f32_dpp v9, v9, v9 quad_perm:[1,0,3,2] row_mask:0xf bank_mask:0xf
    s_nop 1
    v_add_f32_dpp v9, v9, v9 quad_perm:[2,3,0,1] row_mask:0xf bank_mask:0xf
    s_nop 1
    v_add_f32_dpp v9, v9, v9 row_half_mirror row_mask:0xf bank_mask:0xf
    s_nop 1
    v_add_f32_dpp v9, v9, v9 row_mirror row_mask:0xf bank_mask:0xf
    v_mov_b32 v10, v9
    s_nop 1
    v_permlane32_swap_b32 v9, v10
    v_add_f32 v9, v9, v10
    v_mov_b32 v10, v9
    s_nop 1
    v_permlane16_swap_b32 v9, v10
    v_add_f32 v9, v9, v10
    v_mul_f32 v9, 0x3acccccd, v9
    v_cvt_pk_bf16_f32 v8, v8, v9
    v_and_b32 v9, 0xffff0000, v8
    v_lshlrev_b32 v8, 16, v8
    v_add_f32 v9, 0x3727c5ac, v9
    v_cvt_pk_bf16_f32 v9, v9, v9
    v_lshlrev_b32 v9, 16, v9
    v_sqrt_f32 v9, v9
    s_nop 0
    v_cvt_pk_bf16_f32 v9, v9, v9
    v_lshlrev_b32 v9, 16, v9
    v_rcp_f32 v10, v9
    v_add_u32 v11, 122880, v11
    v_fma_f32 v17, -v9, v10, 1.0
    v_fmac_f32 v10, v17, v10
    v_sub_f32 v20, v20, v8
    v_sub_f32 v21, v21, v8
    v_cvt_pk_bf16_f32 v12, v20, v21
    v_lshlrev_b32 v13, 16, v12
    v_and_b32 v14, 0xffff0000, v12
    v_mul_f32 v13, v13, v10
    v_mul_f32 v14, v14, v10
    v_cvt_pk_bf16_f32 v12, v13, v14
    ds_write_b32 v11, v12 offset:0
    v_sub_f32 v22, v22, v8
    v_sub_f32 v23, v23, v8
    v_cvt_pk_bf16_f32 v12, v22, v23
    v_lshlrev_b32 v13, 16, v12
    v_and_b32 v14, 0xffff0000, v12
    v_mul_f32 v13, v13, v10
    v_mul_f32 v14, v14, v10
    v_cvt_pk_bf16_f32 v12, v13, v14
    ds_write_b32 v11, v12 offset:256
    v_sub_f32 v24, v24, v8
    v_sub_f32 v25, v25, v8
    v_cvt_pk_bf16_f32 v12, v24, v25
    v_lshlrev_b32 v13, 16, v12
    v_and_b32 v14, 0xffff0000, v12
    v_mul_f32 v13, v13, v10
    v_mul_f32 v14, v14, v10
    v_cvt_pk_bf16_f32 v12, v13, v14
    ds_write_b32 v11, v12 offset:512
    v_sub_f32 v26, v26, v8
    v_sub_f32 v27, v27, v8
    v_cvt_pk_bf16_f32 v12, v26, v27
    v_lshlrev_b32 v13, 16, v12
    v_and_b32 v14, 0xffff0000, v12
    v_mul_f32 v13, v13, v10
    v_mul_f32 v14, v14, v10
    v_cvt_pk_bf16_f32 v12, v13, v14
    ds_write_b32 v11, v12 offset:768
    v_sub_f32 v28, v28, v8
    v_sub_f32 v29, v29, v8
    v_cvt_pk_bf16_f32 v12, v28, v29
    v_lshlrev_b32 v13, 16, v12
    v_and_b32 v14, 0xffff0000, v12
    v_mul_f32 v13, v13, v10
    v_mul_f32 v14, v14, v10
    v_cvt_pk_bf16_f32 v12, v13, v14
    ds_write_b32 v11, v12 offset:1024
Lnoln_6:
    s_waitcnt lgkmcnt(0)
    s_add_u32 s49, s49, 1
    v_mov_b32 v6, s49
    s_cmp_ge_u32 s48, 16
    s_cbranch_scc1 LC_PATH
    v_lshl_add_u32 v26, v2, 2, v4
    v_and_b32 v27, 7, v26
    v_xor_b32 v28, s44, v27
    v_lshlrev_b32 v28, 5, v28
    v_lshl_add_u32 v28, v26, 8, v28
    v_lshl_add_u32 v8, v5, 3, v28
    v_lshlrev_b32 v10, 2, v1
    v_lshlrev_b32 v41, 4, v1
    v_lshlrev_b32 v22, 4, v0
    s_lshl_b32 s53, s44, 1
    v_xor_b32 v11, s53, v1
    v_lshlrev_b32 v11, 4, v11
    s_and_b32 s97, s48, 1
    s_lshr_b32 s98, s48, 1
    s_lshl3_add_u32 s98, s47, s98
    s_mov_b32 s32, s6
    s_mov_b32 s33, s7
    s_mov_b32 s34, 4194304
    s_cmp_ge_u32 s44, 4
    s_cbranch_scc1 Lapv_7
    v_and_b32 v26, 7, v3
    v_lshlrev_b32 v26, 1, v26
    v_lshlrev_b32 v27, 10, v3
    s_lshl_b32 s53, s44, 14
    s_add_u32 s53, s53, 40960
    v_add_u32 v28, 0, v2
    v_xor_b32 v28, v28, v26
    v_lshl_add_u32 v28, v28, 4, v27
    v_add_u32 v12, s53, v28
    v_add_u32 v16, 106496, v28
    v_add_u32 v28, 4, v2
    v_xor_b32 v28, v28, v26
    v_lshl_add_u32 v28, v28, 4, v27
    v_add_u32 v13, s53, v28
    v_add_u32 v17, 106496, v28
    v_add_u32 v28, 8, v2
    v_xor_b32 v28, v28, v26
    v_lshl_add_u32 v28, v28, 4, v27
    v_add_u32 v14, s53, v28
    v_add_u32 v18, 106496, v28
    v_add_u32 v28, 12, v2
    v_xor_b32 v28, v28, v26
    v_lshl_add_u32 v28, v28, 4, v27
    v_add_u32 v15, s53, v28
    v_add_u32 v19, 106496, v28
    s_branch Laj_8
Lapv_7:
    v_lshlrev_b32 v26, 10, v26
    v_lshl_add_u32 v26, v5, 3, v26
    s_lshl_b32 s53, s44, 8
    s_add_u32 s53, s53, 39936
    v_add_u32 v26, s53, v26
    v_xor_b32 v28, 0, v27
    v_lshl_add_u32 v12, v28, 5, v26
    v_xor_b32 v28, 1, v27
    v_lshl_add_u32 v13, v28, 5, v26
    v_xor_b32 v28, 2, v27
    v_lshl_add_u32 v14, v28, 5, v26
    v_xor_b32 v28, 3, v27
    v_lshl_add_u32 v15, v28, 5, v26
    v_xor_b32 v28, 4, v27
    v_lshl_add_u32 v16, v28, 5, v26
    v_xor_b32 v28, 5, v27
    v_lshl_add_u32 v17, v28, 5, v26
    v_xor_b32 v28, 6, v27
    v_lshl_add_u32 v18, v28, 5, v26
    v_xor_b32 v28, 7, v27
    v_lshl_add_u32 v19, v28, 5, v26
Laj_8:
    s_movk_i32 s53, 4608
    v_lshlrev_b32 v26, 4, v3
    v_mad_u32_u24 v21, v2, s53, v26
    v_add_u32 v32, 124160, v26
    s_lshl_b32 s53, s44, 2
    v_add_u32 v23, s53, v32
    v_lshrrev_b32 v26, 1, v4
    v_and_b32 v27, 1, v4
    v_lshlrev_b32 v26, 8, v26
    v_lshl_add_u32 v26, v27, 6, v26
    v_lshl_add_u32 v20, v5, 2, v26
    v_and_b32 v26, 127, v0
    v_lshrrev_b32 v27, 1, v26
    v_and_b32 v26, 1, v26
    s_lshr_b32 s53, s44, 1
    s_lshl_b32 s58, s53, 10
    s_add_u32 s58, s58, 106496
    v_lshl_add_u32 v26, v26, 3, s58
    s_lshl_b32 s53, s53, 1
    v_xor_b32 v28, s53, v27
    v_lshl_add_u32 v24, v28, 4, v26
    v_xor_b32 v28, 8, v28
    v_lshl_add_u32 v25, v28, 4, v26
    v_mul_u32_u24 v26, 160, v3
    v_lshl_add_u32 v26, v2, 4, v26
    v_add_u32 v30, 124672, v26
    s_bfe_u32 s53, s44, 0x10001
    s_and_b32 s58, s44, 1
    s_lshl3_add_u32 s53, s53, s58
    s_lshl_b32 s53, s53, 3
    v_add_u32 v33, s53, v30
    s_movk_i32 s53, 3277
    s_movk_i32 s58, 960
    v_add_u32 v26, 0, v1
    v_mul_u32_u24 v27, s53, v26
    v_lshrrev_b32 v27, 16, v27
    v_lshrrev_b32 v28, 1, v27
    v_and_b32 v28, 2, v28
    v_xor_b32 v26, v26, v28
    v_lshlrev_b32 v26, 4, v26
    v_mad_u32_u24 v34, v27, s58, v26
    v_add_u32 v26, 64, v1
    v_mul_u32_u24 v27, s53, v26
    v_lshrrev_b32 v27, 16, v27
    v_lshrrev_b32 v28, 1, v27
    v_and_b32 v28, 2, v28
    v_xor_b32 v26, v26, v28
    v_lshlrev_b32 v26, 4, v26
    v_mad_u32_u24 v35, v27, s58, v26
    v_add_u32 v26, 128, v1
    v_mul_u32_u24 v27, s53, v26
    v_lshrrev_b32 v27, 16, v27
    v_lshrrev_b32 v28, 1, v27
    v_and_b32 v28, 2, v28
    v_xor_b32 v26, v26, v28
    v_lshlrev_b32 v26, 4, v26
    v_mad_u32_u24 v36, v27, s58, v26
    v_add_u32 v26, 192, v1
    v_mul_u32_u24 v27, s53, v26
    v_lshrrev_b32 v27, 16, v27
    v_lshrrev_b32 v28, 1, v27
    v_and_b32 v28, 2, v28
    v_xor_b32 v26, v26, v28
    v_lshlrev_b32 v26, 4, v26
    v_mad_u32_u24 v37, v27, s58, v26
    v_add_u32 v26, 256, v1
    v_mul_u32_u24 v27, s53, v26
    v_lshrrev_b32 v27, 16, v27
    v_lshrrev_b32 v28, 1, v27
    v_and_b32 v28, 2, v28
    v_xor_b32 v26, v26, v28
    v_lshlrev_b32 v26, 4, v26
    v_mad_u32_u24 v38, v27, s58, v26
    v_lshl_add_u32 v26, v2, 2, v4
    v_mul_u32_u24 v26, 320, v26
    v_lshl_add_u32 v26, v5, 3, v26
    s_lshl_b32 s53, s44, 6
    s_add_u32 s53, s53, 0
    v_add_u32 v26, s53, v26
    v_and_b32 v27, 1, v2
    v_lshl_add_u32 v39, v27, 5, v26
    v_xor_b32 v27, 1, v27
    v_lshl_add_u32 v40, v27, 5, v26
    s_lshl_b32 s62, s45, 11
    s_lshl4_add_u32 s62, s46, s62
    s_lshr_b32 s53, s44, 2
    s_lshl_b32 s53, s53, 10
    s_add_u32 s62, s62, s53
    s_and_b32 s53, s44, 1
    s_lshl_b32 s53, s53, 9
    s_add_u32 s62, s62, s53
    s_and_b32 s53, s44, 2
    s_lshl_b32 s53, s53, 6
    s_add_u32 s62, s62, s53
    s_add_u32 s62, s62, 131072
    s_lshl2_add_u32 s63, s45, s46
    s_lshl3_add_u32 s63, s63, s44
    s_lshl_b32 s63, s63, 7
    s_add_u32 s63, s63, 4521984
    s_lshl_b32 s99, s97, 15
    s_add_u32 s99, s99, 65536
    s_mul_i32 s16, s98, 37120
    s_mul_i32 s53, s97, 18432
    s_add_u32 s16, s16, s53
    s_add_u32 s16, s16, 2097152
    s_and_b32 s53, s44, 3
    s_lshl_b32 s53, s53, 8
    s_add_u32 s17, s16, s53
    s_barrier
    s_mul_i32 s53, s46, 320
    s_add_u32 s53, s53, 122880
    v_lshl_add_u32 v9, v2, 3, s53
    ds_read2_b64 v[128:131], v9 offset0:0 offset1:4
    ds_read2_b64 v[132:135], v9 offset0:8 offset1:12
    ds_read2_b64 v[136:139], v9 offset0:16 offset1:20
    ds_read2_b64 v[140:143], v9 offset0:24 offset1:28
    ds_read2_b64 v[144:147], v9 offset0:32 offset1:36
    v_mov_b32 v26, 0xff800000
    ds_write_b32 v32, v26
    s_waitcnt vmcnt(4)
    s_lshl_b32 s53, s97, 5
    s_add_u32 s53, s53, s44
    s_lshl_b32 s53, s53, 10
    s_add_u32 s51, s53, 40960
    s_lshl_b32 s50, s98, 16
    s_add_u32 s50, s50, s53
    s_mov_b32 m0, s51
    s_nop 0
    buffer_load_dwordx4 v11, s[32:35], s50 offen nt lds
    s_add_u32 s51, s51, 8192
    s_add_u32 s50, s50, 8192
    s_getreg_b32 s53, hwreg(HW_REG_XCC_ID, 0, 4)
    v_perm_b32 v31, v6, v6, v62
    v_mov_b32 v26, s53
    v_cmp_eq_u32 vcc, 1, v5
    s_nop 1
    v_cndmask_b32 v31, v31, v26, vcc
    s_waitcnt vmcnt(3) lgkmcnt(0)
    s_barrier
    ds_read_b64_tr_b16 v[64:65], v8 offset:0
    ds_read_b64_tr_b16 v[66:67], v8 offset:4096
    ds_read_b64_tr_b16 v[68:69], v8 offset:8192
    ds_read_b64_tr_b16 v[70:71], v8 offset:12288
    ds_read_b64_tr_b16 v[72:73], v8 offset:16384
    ds_read_b64_tr_b16 v[74:75], v8 offset:20480
    s_waitcnt lgkmcnt(4)
    v_mfma_f32_16x16x32_bf16 v[44:47], v[128:131], v[64:67], 0
    s_waitcnt lgkmcnt(2)
    v_mfma_f32_16x16x32_bf16 v[44:47], v[132:135], v[68:71], v[44:47]
    s_waitcnt lgkmcnt(0)
    v_mfma_f32_16x16x32_bf16 v[44:47], v[136:139], v[72:75], v[44:47]
    s_waitcnt vmcnt(1) lgkmcnt(0)
    s_barrier
    ds_read_b64_tr_b16 v[76:77], v8 offset:24576
    ds_read_b64_tr_b16 v[78:79], v8 offset:28672
    ds_read_b64_tr_b16 v[80:81], v8 offset:32768
    ds_read_b64_tr_b16 v[82:83], v8 offset:36864
    s_waitcnt lgkmcnt(2)
    v_mfma_f32_16x16x32_bf16 v[44:47], v[140:143], v[76:79], v[44:47]
    s_waitcnt lgkmcnt(0)
    v_mfma_f32_16x16x32_bf16 v[44:47], v[144:147], v[80:83], v[44:47]
    s_mov_b64 exec, 0xffff
    s_nop 6
    v_cvt_pk_bf16_f32 v44, v44, v44
    v_perm_b32 v44, v44, v31, s60
    buffer_store_dword v44, v20, s[36:39], s62 offen
    s_mov_b64 exec, -1
    s_barrier
    s_mov_b32 m0, s51
    s_add_u32 s51, s51, 8192
    buffer_load_dwordx4 v11, s[32:35], s50 offen nt lds
    s_add_u32 s50, s50, 8192
    s_mov_b32 m0, s51
    s_add_u32 s51, s51, 8192
    buffer_load_dwordx4 v11, s[32:35], s50 offen nt lds
    s_add_u32 s50, s50, 8192
    s_mov_b32 m0, s51
    s_nop 0
    buffer_load_dwordx4 v11, s[32:35], s50 offen nt lds
    s_xor_b32 s53, s97, 1
    s_lshl_b32 s53, s53, 5
    s_add_u32 s53, s53, s44
    s_lshl_b32 s53, s53, 10
    s_add_u32 s51, s53, 40960
    s_lshl_b32 s50, s98, 16
    s_add_u32 s50, s50, s53
    s_mov_b32 m0, s51
    s_add_u32 s51, s51, 8192
    buffer_load_dwordx4 v11, s[32:35], s50 offen nt lds
    s_add_u32 s50, s50, 8192
    s_mov_b32 m0, s51
    s_add_u32 s51, s51, 8192
    buffer_load_dwordx4 v11, s[32:35], s50 offen nt lds
    s_add_u32 s50, s50, 8192
    s_mov_b32 m0, s51
    s_add_u32 s51, s51, 8192
    buffer_load_dwordx4 v11, s[32:35], s50 offen nt lds
    s_add_u32 s50, s50, 8192
    s_mov_b32 m0, s51
    s_nop 0
    buffer_load_dwordx4 v11, s[32:35], s50 offen nt lds
    s_mov_b64 exec, 0xffff
    buffer_store_dword v44, v10, s[36:39], s63 offen sc1
    s_mov_b64 exec, -1
    s_branch LPAGE1
Lslow_19:
    s_mov_b64 exec, -1
    s_lshl_b32 s50, s45, 12
    s_add_u32 s50, s50, 4653056
    v_lshlrev_b32 v28, 10, v5
    v_lshl_add_u32 v28, v4, 7, v28
    v_lshl_add_u32 v28, v2, 4, v28
Lpds_21:
    buffer_load_dwordx4 v[64:67], v28, s[36:39], s50 offen offset:0 sc1
    buffer_load_dwordx4 v[68:71], v28, s[36:39], s50 offen offset:512 sc1
    s_add_u32 s52, s52, 1
    s_cmp_gt_u32 s52, 400000
    s_cbranch_scc1 LEXIT
    s_waitcnt vmcnt(1)
    v_perm_b32 v26, v67, v64, s60
    v_cmp_ne_u32 vcc, v26, v6
    s_waitcnt vmcnt(0)
    v_perm_b32 v26, v71, v68, s60
    v_cmp_ne_u32 s[56:57], v26, v6
    s_or_b64 vcc, vcc, s[56:57]
    s_cbranch_scc1 Lpds_21
    s_branch Lpdd_20
Lslow_26:
    s_mov_b64 exec, -1
    s_lshl_b32 s50, s45, 12
    s_add_u32 s50, s50, 4521984
    v_lshlrev_b32 v16, 10, v5
    v_and_b32 v14, 2, v4
    v_lshl_add_u32 v16, v14, 7, v16
    v_lshrrev_b32 v14, 1, v2
    v_lshl_add_u32 v16, v14, 7, v16
    v_and_b32 v14, 1, v2
    v_lshl_add_u32 v16, v14, 5, v16
    v_and_b32 v14, 1, v4
    v_lshl_add_u32 v16, v14, 4, v16
Lpds_28:
    buffer_load_dwordx4 v[96:99], v16, s[36:39], s50 offen offset:0 sc1
    buffer_load_dwordx4 v[100:103], v16, s[36:39], s50 offen offset:512 sc1
    s_add_u32 s52, s52, 1
    s_cmp_gt_u32 s52, 400000
    s_cbranch_scc1 LEXIT
    s_waitcnt vmcnt(1)
    v_perm_b32 v14, v99, v96, s60
    v_cmp_ne_u32 vcc, v14, v6
    s_waitcnt vmcnt(0)
    v_perm_b32 v14, v103, v100, s60
    v_cmp_ne_u32 s[56:57], v14, v6
    s_or_b64 vcc, vcc, s[56:57]
    s_cbranch_scc1 Lpds_28
    s_branch Lpdd_27
Lslow_41:
    s_mov_b64 exec, -1
    s_lshl_b32 s50, s45, 11
    s_add_u32 s50, s50, 4784128
    v_lshlrev_b32 v16, 9, v5
    v_lshl_add_u32 v16, v4, 7, v16
    v_lshl_add_u32 v16, v2, 4, v16
Lpds_43:
    buffer_load_dwordx4 v[84:87], v16, s[36:39], s50 offen offset:0 sc1
    s_add_u32 s52, s52, 1
    s_cmp_gt_u32 s52, 400000
    s_cbranch_scc1 LEXIT
    s_waitcnt vmcnt(0)
    v_perm_b32 v14, v85, v84, s59
    v_perm_b32 v15, v87, v86, s59
    v_lshl_or_b32 v14, v15, 16, v14
    v_cmp_ne_u32 vcc, v14, v6
    s_cbranch_vccnz Lpds_43
    s_branch Lpdd_42
    .p2align 12
LPAGE1:
    s_waitcnt vmcnt(2)
    s_add_u32 s50, s99, 0
    buffer_load_dwordx4 v[96:99], v22, s[36:39], s50 offen sc1
    s_add_u32 s50, s99, 8192
    buffer_load_dwordx4 v[100:103], v22, s[36:39], s50 offen sc1
    s_add_u32 s50, s99, 16384
    buffer_load_dwordx4 v[104:107], v22, s[36:39], s50 offen sc1
    s_add_u32 s50, s99, 24576
    buffer_load_dwordx4 v[108:111], v22, s[36:39], s50 offen sc1
    s_mov_b32 s32, s14
    s_mov_b32 s33, s15
    s_mov_b32 s34, 5242880
    s_mov_b32 s52, 0
    s_waitcnt vmcnt(5)
    s_barrier
    s_cmp_ge_u32 s44, 4
    s_cbranch_scc1 Lnsa_10
    ds_read_b128 v[192:195], v12 offset:0
    ds_read_b128 v[196:199], v13 offset:0
    ds_read_b128 v[200:203], v14 offset:0
    ds_read_b128 v[204:207], v15 offset:0
    ds_read_b128 v[208:211], v12 offset:256
    ds_read_b128 v[212:215], v13 offset:256
    ds_read_b128 v[216:219], v14 offset:256
    ds_read_b128 v[220:223], v15 offset:256
    ds_read_b128 v[224:227], v12 offset:512
    ds_read_b128 v[228:231], v13 offset:512
    ds_read_b128 v[232:235], v14 offset:512
    ds_read_b128 v[236:239], v15 offset:512
    ds_read_b128 v[240:243], v12 offset:768
    ds_read_b128 v[244:247], v13 offset:768
    ds_read_b128 v[248:251], v14 offset:768
    ds_read_b128 v[252:255], v15 offset:768
    s_branch Lqchk_11
Lnsa_10:
    ds_read_b64_tr_b16 v[192:193], v12 offset:0
    ds_read_b64_tr_b16 v[194:195], v12 offset:16384
    ds_read_b64_tr_b16 v[196:197], v12 offset:32768
    ds_read_b64_tr_b16 v[198:199], v12 offset:49152
    ds_read_b64_tr_b16 v[200:201], v13 offset:0
    ds_read_b64_tr_b16 v[202:203], v13 offset:16384
    ds_read_b64_tr_b16 v[204:205], v13 offset:32768
    ds_read_b64_tr_b16 v[206:207], v13 offset:49152
    ds_read_b64_tr_b16 v[208:209], v14 offset:0
    ds_read_b64_tr_b16 v[210:211], v14 offset:16384
    ds_read_b64_tr_b16 v[212:213], v14 offset:32768
    ds_read_b64_tr_b16 v[214:215], v14 offset:49152
    ds_read_b64_tr_b16 v[216:217], v15 offset:0
    ds_read_b64_tr_b16 v[218:219], v15 offset:16384
    ds_read_b64_tr_b16 v[220:221], v15 offset:32768
    ds_read_b64_tr_b16 v[222:223], v15 offset:49152
    ds_read_b64_tr_b16 v[224:225], v16 offset:0
    ds_read_b64_tr_b16 v[226:227], v16 offset:16384
    ds_read_b64_tr_b16 v[228:229], v16 offset:32768
    ds_read_b64_tr_b16 v[230:231], v16 offset:49152
    ds_read_b64_tr_b16 v[232:233], v17 offset:0
    ds_read_b64_tr_b16 v[234:235], v17 offset:16384
    ds_read_b64_tr_b16 v[236:237], v17 offset:32768
    ds_read_b64_tr_b16 v[238:239], v17 offset:49152
    ds_read_b64_tr_b16 v[240:241], v18 offset:0
    ds_read_b64_tr_b16 v[242:243], v18 offset:16384
    ds_read_b64_tr_b16 v[244:245], v18 offset:32768
    ds_read_b64_tr_b16 v[246:247], v18 offset:49152
    ds_read_b64_tr_b16 v[248:249], v19 offset:0
    ds_read_b64_tr_b16 v[250:251], v19 offset:16384
    ds_read_b64_tr_b16 v[252:253], v19 offset:32768
    ds_read_b64_tr_b16 v[254:255], v19 offset:49152
    s_branch Lqchk_11
Lqa_9:
    s_add_u32 s50, s99, 0
    buffer_load_dwordx4 v[96:99], v22, s[36:39], s50 offen sc1
    s_add_u32 s50, s99, 8192
    buffer_load_dwordx4 v[100:103], v22, s[36:39], s50 offen sc1
    s_add_u32 s50, s99, 16384
    buffer_load_dwordx4 v[104:107], v22, s[36:39], s50 offen sc1
    s_add_u32 s50, s99, 24576
    buffer_load_dwordx4 v[108:111], v22, s[36:39], s50 offen sc1
    s_add_u32 s52, s52, 1
    s_cmp_gt_u32 s52, 400000
    s_cbranch_scc1 LEXIT
Lqchk_11:
    s_waitcnt vmcnt(3)
    v_perm_b32 v112, v97, v96, s61
    v_perm_b32 v113, v99, v98, s61
    ds_write_b64 v24, v[112:113] offset:0
    v_perm_b32 v26, v99, v96, s60
    v_cmp_ne_u32 s[54:55], v26, v6
    s_waitcnt vmcnt(2)
    v_perm_b32 v114, v101, v100, s61
    v_perm_b32 v115, v103, v102, s61
    ds_write_b64 v25, v[114:115] offset:4096
    v_perm_b32 v26, v103, v100, s60
    v_cmp_ne_u32 vcc, v26, v6
    s_or_b64 s[54:55], s[54:55], vcc
    s_waitcnt vmcnt(1)
    v_perm_b32 v116, v105, v104, s61
    v_perm_b32 v117, v107, v106, s61
    ds_write_b64 v24, v[116:117] offset:8192
    v_perm_b32 v26, v107, v104, s60
    v_cmp_ne_u32 vcc, v26, v6
    s_or_b64 s[54:55], s[54:55], vcc
    s_waitcnt vmcnt(0)
    v_perm_b32 v118, v109, v108, s61
    v_perm_b32 v119, v111, v110, s61
    ds_write_b64 v25, v[118:119] offset:12288
    v_perm_b32 v26, v111, v108, s60
    v_cmp_ne_u32 vcc, v26, v6
    s_or_b64 s[54:55], s[54:55], vcc
    s_mov_b64 exec, s[54:55]
    s_cbranch_scc1 Lqa_9
    s_mov_b64 exec, -1
    s_waitcnt lgkmcnt(0)
    s_cmp_ge_u32 s44, 4
    s_barrier
    s_cbranch_scc1 Lpvw_12
    ds_read_b128 v[64:67], v16 offset:0
    ds_read_b128 v[68:71], v17 offset:0
    ds_read_b128 v[72:75], v18 offset:0
    ds_read_b128 v[76:79], v19 offset:0
    ds_read_b128 v[80:83], v16 offset:256
    ds_read_b128 v[84:87], v17 offset:256
    ds_read_b128 v[88:91], v18 offset:256
    ds_read_b128 v[92:95], v19 offset:256
    ds_read_b128 v[96:99], v16 offset:512
    ds_read_b128 v[100:103], v17 offset:512
    ds_read_b128 v[104:107], v18 offset:512
    ds_read_b128 v[108:111], v19 offset:512
    ds_read_b128 v[112:115], v16 offset:768
    ds_read_b128 v[116:119], v17 offset:768
    ds_read_b128 v[120:123], v18 offset:768
    ds_read_b128 v[124:127], v19 offset:768
    s_waitcnt lgkmcnt(15)
    v_mfma_f32_16x16x32_bf16 v[44:47], v[192:195], v[64:67], 0
    s_waitcnt lgkmcnt(14)
    v_mfma_f32_16x16x32_bf16 v[44:47], v[196:199], v[68:71], v[44:47]
    s_waitcnt lgkmcnt(13)
    v_mfma_f32_16x16x32_bf16 v[44:47], v[200:203], v[72:75], v[44:47]
    s_waitcnt lgkmcnt(12)
    v_mfma_f32_16x16x32_bf16 v[44:47], v[204:207], v[76:79], v[44:47]
    s_waitcnt lgkmcnt(11)
    v_mfma_f32_16x16x32_bf16 v[44:47], v[208:211], v[80:83], v[44:47]
    s_waitcnt lgkmcnt(10)
    v_mfma_f32_16x16x32_bf16 v[44:47], v[212:215], v[84:87], v[44:47]
    s_waitcnt lgkmcnt(9)
    v_mfma_f32_16x16x32_bf16 v[44:47], v[216:219], v[88:91], v[44:47]
    s_waitcnt lgkmcnt(8)
    v_mfma_f32_16x16x32_bf16 v[44:47], v[220:223], v[92:95], v[44:47]
    s_waitcnt lgkmcnt(7)
    v_mfma_f32_16x16x32_bf16 v[44:47], v[224:227], v[96:99], v[44:47]
    s_waitcnt lgkmcnt(6)
    v_mfma_f32_16x16x32_bf16 v[44:47], v[228:231], v[100:103], v[44:47]
    s_waitcnt lgkmcnt(5)
    v_mfma_f32_16x16x32_bf16 v[44:47], v[232:235], v[104:107], v[44:47]
    s_waitcnt lgkmcnt(4)
    v_mfma_f32_16x16x32_bf16 v[44:47], v[236:239], v[108:111], v[44:47]
    s_waitcnt lgkmcnt(3)
    v_mfma_f32_16x16x32_bf16 v[44:47], v[240:243], v[112:115], v[44:47]
    s_waitcnt lgkmcnt(2)
    v_mfma_f32_16x16x32_bf16 v[44:47], v[244:247], v[116:119], v[44:47]
    s_waitcnt lgkmcnt(1)
    v_mfma_f32_16x16x32_bf16 v[44:47], v[248:251], v[120:123], v[44:47]
    s_waitcnt lgkmcnt(0)
    v_mfma_f32_16x16x32_bf16 v[44:47], v[252:255], v[124:127], v[44:47]
    s_nop 7
    v_max3_f32 v26, v44, v45, v46
    v_max_f32 v26, v26, v47
    ds_max_f32 v32, v26
    s_waitcnt lgkmcnt(0)
    s_barrier
    ds_read_b32 v52, v32
    s_waitcnt lgkmcnt(0)
    v_sub_f32 v44, v44, v52
    v_sub_f32 v45, v45, v52
    v_sub_f32 v46, v46, v52
    v_sub_f32 v47, v47, v52
    v_exp_f32 v44, v44
    v_exp_f32 v45, v45
    v_exp_f32 v46, v46
    v_exp_f32 v47, v47
    v_cvt_pk_bf16_f32 v48, v44, v45
    v_cvt_pk_bf16_f32 v49, v46, v47
    ds_write_b64 v33, v[48:49]
    s_cmp_lg_u32 s44, 0
    s_waitcnt lgkmcnt(0)
    s_barrier
    s_cbranch_scc1 Lnst_13
    ds_read_b128 v[64:67], v30
    ds_read_b128 v[68:71], v30 offset:64
    v_mov_b32 v72, 0x3f803f80
    v_mov_b32 v73, v72
    v_mov_b32 v74, v72
    v_mov_b32 v75, v72
    v_mul_u32_u24 v26, 1152, v3
    s_waitcnt lgkmcnt(0)
    v_mfma_f32_16x16x32_bf16 v[44:47], v[72:75], v[64:67], 0
    v_mfma_f32_16x16x32_bf16 v[44:47], v[72:75], v[68:71], v[44:47]
    s_mov_b64 exec, 0xffff
    s_nop 6
    v_mov_b32 v45, v6
    buffer_store_dwordx2 v[44:45], v26, s[36:39], s16 offen offset:1024 sc1
    s_mov_b64 exec, -1
    s_branch Lnst_13
Lpvw_12:
    s_lshl3_add_u32 s53, s45, s44
    s_mul_i32 s50, s53, 20480
    s_mul_i32 s53, s46, 320
    s_add_u32 s50, s50, s53
    s_mul_i32 s51, s44, 5120
    s_mov_b32 m0, s51
    s_add_u32 s51, s51, 1024
    buffer_load_dwordx4 v34, s[32:35], s50 offen nt lds
    s_mov_b32 m0, s51
    s_nop 0
    buffer_load_dwordx4 v35, s[32:35], s50 offen nt lds
    v_lshlrev_b32 v26, 9, v3
    v_mov_b32 v53, v6
    s_lshl_b32 s50, s97, 13
    s_lshr_b32 s53, s48, 1
    s_lshl_b32 s53, s53, 6
    s_add_u32 s50, s50, s53
    s_lshl3_add_u32 s50, s47, s50
    s_add_u32 s50, s50, 720896
    s_cmp_lg_u32 s44, 4
    s_barrier
    s_cbranch_scc1 Lnm_15
    ds_read_b32 v52, v32
    s_mov_b64 exec, 0xffff
    s_waitcnt lgkmcnt(0)
    buffer_store_dwordx2 v[52:53], v26, s[36:39], s50 offen sc1
    s_mov_b64 exec, -1
Lnm_15:
    s_barrier
    ds_read_b128 v[64:67], v30
    ds_read_b128 v[68:71], v30 offset:64
    s_waitcnt lgkmcnt(1)
    v_mfma_f32_16x16x32_bf16 v[72:75], v[64:67], v[192:195], 0
    v_mfma_f32_16x16x32_bf16 v[76:79], v[64:67], v[200:203], 0
    s_waitcnt lgkmcnt(0)
    v_mfma_f32_16x16x32_bf16 v[72:75], v[68:71], v[196:199], v[72:75]
    v_mfma_f32_16x16x32_bf16 v[76:79], v[68:71], v[204:207], v[76:79]
    v_mfma_f32_16x16x32_bf16 v[80:83], v[64:67], v[208:211], 0
    v_mfma_f32_16x16x32_bf16 v[84:87], v[64:67], v[216:219], 0
    v_mfma_f32_16x16x32_bf16 v[80:83], v[68:71], v[212:215], v[80:83]
    v_mfma_f32_16x16x32_bf16 v[84:87], v[68:71], v[220:223], v[84:87]
    v_mfma_f32_16x16x32_bf16 v[88:91], v[64:67], v[224:227], 0
    v_mfma_f32_16x16x32_bf16 v[92:95], v[64:67], v[232:235], 0
    v_mfma_f32_16x16x32_bf16 v[88:91], v[68:71], v[228:231], v[88:91]
    v_mfma_f32_16x16x32_bf16 v[92:95], v[68:71], v[236:239], v[92:95]
    v_cvt_pk_bf16_f32 v104, v72, v76
    v_cvt_pk_bf16_f32 v108, v73, v77
    v_cvt_pk_bf16_f32 v112, v74, v78
    v_cvt_pk_bf16_f32 v116, v75, v79
    v_mfma_f32_16x16x32_bf16 v[96:99], v[64:67], v[240:243], 0
    v_mfma_f32_16x16x32_bf16 v[100:103], v[64:67], v[248:251], 0
    v_mfma_f32_16x16x32_bf16 v[96:99], v[68:71], v[244:247], v[96:99]
    v_mfma_f32_16x16x32_bf16 v[100:103], v[68:71], v[252:255], v[100:103]
    v_cvt_pk_bf16_f32 v105, v80, v84
    v_cvt_pk_bf16_f32 v109, v81, v85
    v_cvt_pk_bf16_f32 v113, v82, v86
    v_cvt_pk_bf16_f32 v117, v83, v87
    v_cvt_pk_bf16_f32 v106, v88, v92
    v_cvt_pk_bf16_f32 v110, v89, v93
    v_cvt_pk_bf16_f32 v114, v90, v94
    v_cvt_pk_bf16_f32 v118, v91, v95
    v_cvt_pk_bf16_f32 v107, v96, v100
    buffer_store_dwordx4 v[104:107], v21, s[36:39], s17 offen offset:0 sc1
    v_cvt_pk_bf16_f32 v111, v97, v101
    buffer_store_dwordx4 v[108:111], v21, s[36:39], s17 offen offset:1152 sc1
    v_cvt_pk_bf16_f32 v115, v98, v102
    buffer_store_dwordx4 v[112:115], v21, s[36:39], s17 offen offset:2304 sc1
    v_cvt_pk_bf16_f32 v119, v99, v103
    buffer_store_dwordx4 v[116:119], v21, s[36:39], s17 offen offset:3456 sc1
Lnst_13:
    s_lshl3_add_u32 s53, s45, s44
    s_mul_i32 s50, s53, 20480
    s_mul_i32 s53, s46, 320
    s_add_u32 s50, s50, s53
    s_mul_i32 s51, s44, 5120
    s_barrier
    s_cmp_ge_u32 s44, 4
    s_cbranch_scc1 Lwop_16
    s_mov_b32 m0, s51
    s_add_u32 s51, s51, 1024
    buffer_load_dwordx4 v34, s[32:35], s50 offen nt lds
    s_mov_b32 m0, s51
    s_nop 0
    buffer_load_dwordx4 v35, s[32:35], s50 offen nt lds
Lwop_16:
    s_mul_i32 s51, s44, 5120
    s_add_u32 s51, s51, 2048
    s_mov_b32 m0, s51
    s_add_u32 s51, s51, 1024
    buffer_load_dwordx4 v36, s[32:35], s50 offen nt lds
    s_mov_b32 m0, s51
    s_add_u32 s51, s51, 1024
    buffer_load_dwordx4 v37, s[32:35], s50 offen nt lds
    s_mov_b32 m0, s51
    s_nop 0
    buffer_load_dwordx4 v38, s[32:35], s50 offen nt lds
    s_mul_i32 s62, s45, 2560
    s_mul_i32 s53, s46, 640
    s_add_u32 s62, s62, s53
    s_lshl_b32 s53, s44, 7
    s_add_u32 s62, s62, s53
    s_add_u32 s62, s62, 524288
    s_lshl_b32 s99, s45, 11
    s_add_u32 s99, s99, 262144
    s_waitcnt vmcnt(0)
    s_cmp_ge_u32 s44, 5
    s_barrier
    s_cbranch_scc1 LEXIT
    s_mov_b32 s52, 0
    s_mov_b64 s[54:55], -1
    s_mov_b64 s[56:57], -1
    buffer_load_dwordx4 v[64:67], v41, s[36:39], s99 offen sc1
    buffer_load_dwordx4 v[68:71], v41, s[36:39], s99 offen offset:1024 sc1
    ds_read_b64_tr_b16 v[128:129], v39 offset:0
    ds_read_b64_tr_b16 v[130:131], v39 offset:5120
    ds_read_b64_tr_b16 v[132:133], v39 offset:10240
    ds_read_b64_tr_b16 v[134:135], v39 offset:15360
    ds_read_b64_tr_b16 v[136:137], v39 offset:20480
    ds_read_b64_tr_b16 v[138:139], v39 offset:25600
    ds_read_b64_tr_b16 v[140:141], v39 offset:30720
    ds_read_b64_tr_b16 v[142:143], v39 offset:35840
    ds_read_b64_tr_b16 v[144:145], v40 offset:0
    ds_read_b64_tr_b16 v[146:147], v40 offset:5120
    ds_read_b64_tr_b16 v[148:149], v40 offset:10240
    ds_read_b64_tr_b16 v[150:151], v40 offset:15360
    ds_read_b64_tr_b16 v[152:153], v40 offset:20480
    ds_read_b64_tr_b16 v[154:155], v40 offset:25600
    ds_read_b64_tr_b16 v[156:157], v40 offset:30720
    ds_read_b64_tr_b16 v[158:159], v40 offset:35840
    s_branch Lpd_18c
Lpd_18:
    s_mov_b64 exec, s[54:55]
    buffer_load_dwordx4 v[64:67], v41, s[36:39], s99 offen sc1
    s_mov_b64 exec, s[56:57]
    buffer_load_dwordx4 v[68:71], v41, s[36:39], s99 offen offset:1024 sc1
    s_add_u32 s52, s52, 1
    s_cmp_gt_u32 s52, 64
    s_cbranch_scc1 Lslow_19
Lpd_18c:
    s_mov_b64 exec, s[54:55]
    s_waitcnt vmcnt(1)
    v_perm_b32 v26, v67, v64, s60
    v_cmp_ne_u32 s[54:55], v26, v6
    s_mov_b64 exec, s[56:57]
    s_waitcnt vmcnt(0)
    v_perm_b32 v26, v71, v68, s60
    v_cmp_ne_u32 s[56:57], v26, v6
    s_or_b64 vcc, s[54:55], s[56:57]
    s_cbranch_scc1 Lpd_18
    s_mov_b64 exec, -1
Lpdd_20:
    v_perm_b32 v72, v65, v64, s61
    v_perm_b32 v73, v67, v66, s61
    v_perm_b32 v80, v69, v68, s61
    v_perm_b32 v81, v71, v70, s61
    v_mov_b32_dpp v74, v72 row_shl:4 row_mask:0xf bank_mask:0xf
    v_mov_b32_dpp v75, v73 row_shl:4 row_mask:0xf bank_mask:0xf
    v_mov_b32_dpp v82, v80 row_shl:4 row_mask:0xf bank_mask:0xf
    v_mov_b32_dpp v83, v81 row_shl:4 row_mask:0xf bank_mask:0xf
    v_mov_b32_dpp v76, v72 row_shl:8 row_mask:0xf bank_mask:0xf
    v_mov_b32_dpp v77, v73 row_shl:8 row_mask:0xf bank_mask:0xf
    v_mov_b32_dpp v84, v80 row_shl:8 row_mask:0xf bank_mask:0xf
    v_mov_b32_dpp v85, v81 row_shl:8 row_mask:0xf bank_mask:0xf
    v_mov_b32_dpp v78, v72 row_shl:12 row_mask:0xf bank_mask:0xf
    v_mov_b32_dpp v79, v73 row_shl:12 row_mask:0xf bank_mask:0xf
    v_mov_b32_dpp v86, v80 row_shl:12 row_mask:0xf bank_mask:0xf
    v_mov_b32_dpp v87, v81 row_shl:12 row_mask:0xf bank_mask:0xf
    s_waitcnt lgkmcnt(0)
    v_mfma_f32_16x16x32_bf16 v[44:47], v[72:75], v[128:131], 0
    v_mfma_f32_16x16x32_bf16 v[48:51], v[72:75], v[144:147], 0
    v_mfma_f32_16x16x32_bf16 v[44:47], v[76:79], v[132:135], v[44:47]
    v_mfma_f32_16x16x32_bf16 v[48:51], v[76:79], v[148:151], v[48:51]
    v_mfma_f32_16x16x32_bf16 v[44:47], v[80:83], v[136:139], v[44:47]
    v_mfma_f32_16x16x32_bf16 v[48:51], v[80:83], v[152:155], v[48:51]
    v_mfma_f32_16x16x32_bf16 v[44:47], v[84:87], v[140:143], v[44:47]
    v_mfma_f32_16x16x32_bf16 v[48:51], v[84:87], v[156:159], v[48:51]
    s_nop 6
    v_add_f32 v44, v44, v45
    v_add_f32 v46, v46, v47
    v_add_f32 v48, v48, v49
    v_add_f32 v50, v50, v51
    v_add_f32 v44, v44, v46
    v_add_f32 v48, v48, v50
    s_nop 1
    v_permlane16_swap_b32 v44, v48
    s_mov_b32 exec_hi, 0
    v_perm_b32 v44, v44, s49, v61
    buffer_store_dword v44, v10, s[36:39], s62 offen sc1
    s_branch LEXIT
LC_PATH:
    v_lshl_add_u32 v38, v5, 2, v2
    v_lshlrev_b32 v38, 1, v38
    s_cmp_ge_u32 s3, 27
    s_cbranch_scc1 Lfin0_22
    s_mov_b32 s40, s20
    s_mov_b32 s41, s21
    s_mov_b32 s42, 3456
    v_lshlrev_b32 v14, 3, v2
    v_lshl_add_u32 v14, v4, 5, v14
    s_lshl_b32 s53, s3, 7
    buffer_load_dwordx2 v[34:35], v14, s[40:43], s53 offen
    s_branch Lj0_23
Lfin0_22:
    s_sub_u32 s53, s3, 27
    s_lshl2_add_u32 s53, s53, s46
    s_and_b32 s98, s44, 1
    s_lshl1_add_u32 s98, s53, s98
    s_lshl_b32 s53, s98, 5
    buffer_load_ushort v36, v38, s[40:43], s53 offen
    s_mov_b32 s40, s24
    s_mov_b32 s41, s25
    s_mov_b32 s42, 1280
    buffer_load_ushort v37, v38, s[40:43], s53 offen
Lj0_23:
    v_and_b32 v14, 7, v3
    v_lshlrev_b32 v14, 1, v14
    s_lshl_b32 s53, s44, 5
    v_add_u32 v15, s53, v3
    v_lshlrev_b32 v15, 8, v15
    v_add_u32 v16, 0, v2
    v_xor_b32 v16, v16, v14
    v_lshl_add_u32 v8, v16, 4, v15
    v_add_u32 v16, 4, v2
    v_xor_b32 v16, v16, v14
    v_lshl_add_u32 v9, v16, 4, v15
    v_add_u32 v16, 8, v2
    v_xor_b32 v16, v16, v14
    v_lshl_add_u32 v10, v16, 4, v15
    v_add_u32 v16, 12, v2
    v_xor_b32 v16, v16, v14
    v_lshl_add_u32 v11, v16, 4, v15
    s_movk_i32 s53, 3277
    s_movk_i32 s58, 960
    v_add_u32 v14, 0, v1
    v_mul_u32_u24 v15, s53, v14
    v_lshrrev_b32 v15, 16, v15
    v_lshrrev_b32 v16, 1, v15
    v_and_b32 v16, 2, v16
    v_xor_b32 v14, v14, v16
    v_lshlrev_b32 v14, 4, v14
    v_mad_u32_u24 v22, v15, s58, v14
    v_add_u32 v14, 64, v1
    v_mul_u32_u24 v15, s53, v14
    v_lshrrev_b32 v15, 16, v15
    v_lshrrev_b32 v16, 1, v15
    v_and_b32 v16, 2, v16
    v_xor_b32 v14, v14, v16
    v_lshlrev_b32 v14, 4, v14
    v_mad_u32_u24 v23, v15, s58, v14
    v_add_u32 v14, 128, v1
    v_mul_u32_u24 v15, s53, v14
    v_lshrrev_b32 v15, 16, v15
    v_lshrrev_b32 v16, 1, v15
    v_and_b32 v16, 2, v16
    v_xor_b32 v14, v14, v16
    v_lshlrev_b32 v14, 4, v14
    v_mad_u32_u24 v24, v15, s58, v14
    v_add_u32 v14, 192, v1
    v_mul_u32_u24 v15, s53, v14
    v_lshrrev_b32 v15, 16, v15
    v_lshrrev_b32 v16, 1, v15
    v_and_b32 v16, 2, v16
    v_xor_b32 v14, v14, v16
    v_lshlrev_b32 v14, 4, v14
    v_mad_u32_u24 v25, v15, s58, v14
    v_add_u32 v14, 256, v1
    v_mul_u32_u24 v15, s53, v14
    v_lshrrev_b32 v15, 16, v15
    v_lshrrev_b32 v16, 1, v15
    v_and_b32 v16, 2, v16
    v_xor_b32 v14, v14, v16
    v_lshlrev_b32 v14, 4, v14
    v_mad_u32_u24 v26, v15, s58, v14
    s_and_b32 s53, s44, 3
    s_lshl_b32 s58, s53, 1
    v_and_b32 v14, 1, v2
    v_add_u32 v15, s58, v14
    v_lshlrev_b32 v15, 1, v15
    v_xor_b32 v15, v15, v3
    v_lshlrev_b32 v16, 13, v2
    v_lshl_add_u32 v20, v15, 4, v16
    v_lshl_add_u32 v14, v4, 1, v14
    v_xor_b32 v14, s44, v14
    v_lshlrev_b32 v14, 5, v14
    v_lshl_add_u32 v15, v4, 4, v2
    v_lshl_add_u32 v14, v15, 8, v14
    v_lshl_add_u32 v14, v5, 3, v14
    v_add_u32 v27, 32768, v14
    v_lshl_add_u32 v14, v2, 2, v4
    v_bfe_u32 v15, v14, 1, 2
    v_xor_b32 v15, s53, v15
    v_lshlrev_b32 v15, 5, v15
    v_lshl_add_u32 v14, v14, 7, v15
    v_lshl_add_u32 v14, v5, 3, v14
    v_add_u32 v28, 65536, v14
    v_lshl_add_u32 v14, v2, 2, v4
    v_mul_u32_u24 v14, 320, v14
    v_lshl_add_u32 v14, v5, 3, v14
    s_lshl_b32 s53, s44, 6
    s_add_u32 s53, s53, 86016
    v_add_u32 v14, s53, v14
    v_and_b32 v15, 1, v2
    v_lshl_add_u32 v29, v15, 5, v14
    v_xor_b32 v15, 1, v15
    v_lshl_add_u32 v30, v15, 5, v14
    s_mul_i32 s53, s46, 320
    s_add_u32 s53, s53, 122880
    v_lshl_add_u32 v31, v2, 3, s53
    v_lshlrev_b32 v32, 8, v4
    v_lshl_add_u32 v32, v5, 2, v32
    s_mul_i32 s53, s44, 288
    s_add_u32 s53, s53, 124672
    v_lshlrev_b32 v14, 4, v3
    v_lshl_add_u32 v14, v2, 2, v14
    v_add_u32 v40, s53, v14
    v_and_b32 v14, 7, v3
    v_mul_u32_u24 v14, 288, v14
    v_lshl_add_u32 v14, v2, 4, v14
    v_add_u32 v41, 124672, v14
    v_lshlrev_b32 v42, 4, v1
    v_lshlrev_b32 v12, 2, v1
    v_and_b32 v14, 1, v3
    v_lshl_add_u32 v14, v14, 2, v2
    s_mov_b32 s53, 296960
    v_mul_u32_u24 v13, s53, v14
    v_mov_b32 v43, 124160
    s_lshl_b32 s99, s45, 11
    s_add_u32 s99, s99, 131072
    s_lshl_b32 s53, s46, 9
    s_add_u32 s58, s99, s53
    s_lshl_b32 s53, s44, 7
    s_add_u32 s58, s58, s53
    s_sub_u32 s58, s58, 65536
    s_mov_b32 s32, s12
    s_mov_b32 s33, s13
    s_mov_b32 s34, 4194304
    s_waitcnt vmcnt(0)
    s_cmp_ge_u32 s44, 4
    s_barrier
    s_cbranch_scc1 Lna2_24
    s_mov_b32 s52, 0
    s_mov_b64 s[54:55], -1
    s_mov_b64 s[56:57], -1
    buffer_load_dwordx4 v[96:99], v42, s[36:39], s99 offen sc1
    buffer_load_dwordx4 v[100:103], v42, s[36:39], s99 offen offset:1024 sc1
    ds_read_b128 v[64:67], v8 offset:0
    ds_read_b128 v[68:71], v9 offset:0
    ds_read_b128 v[72:75], v10 offset:0
    ds_read_b128 v[76:79], v11 offset:0
    ds_read_b128 v[80:83], v8 offset:4096
    ds_read_b128 v[84:87], v9 offset:4096
    ds_read_b128 v[88:91], v10 offset:4096
    ds_read_b128 v[92:95], v11 offset:4096
    s_branch Lpd_25c
Lpd_25:
    s_mov_b64 exec, s[54:55]
    buffer_load_dwordx4 v[96:99], v42, s[36:39], s99 offen sc1
    s_mov_b64 exec, s[56:57]
    buffer_load_dwordx4 v[100:103], v42, s[36:39], s99 offen offset:1024 sc1
    s_add_u32 s52, s52, 1
    s_cmp_gt_u32 s52, 64
    s_cbranch_scc1 Lslow_26
Lpd_25c:
    s_mov_b64 exec, s[54:55]
    s_waitcnt vmcnt(1)
    v_perm_b32 v14, v99, v96, s60
    v_cmp_ne_u32 s[54:55], v14, v6
    s_mov_b64 exec, s[56:57]
    s_waitcnt vmcnt(0)
    v_perm_b32 v14, v103, v100, s60
    v_cmp_ne_u32 s[56:57], v14, v6
    s_or_b64 vcc, s[54:55], s[56:57]
    s_cbranch_scc1 Lpd_25
    s_mov_b64 exec, -1
Lpdd_27:
    v_perm_b32 v104, v97, v96, s61
    v_perm_b32 v105, v99, v98, s61
    v_perm_b32 v112, v101, v100, s61
    v_perm_b32 v113, v103, v102, s61
    v_mov_b32_dpp v106, v104 row_shl:4 row_mask:0xf bank_mask:0xf
    v_mov_b32_dpp v107, v105 row_shl:4 row_mask:0xf bank_mask:0xf
    v_mov_b32_dpp v114, v112 row_shl:4 row_mask:0xf bank_mask:0xf
    v_mov_b32_dpp v115, v113 row_shl:4 row_mask:0xf bank_mask:0xf
    v_mov_b32_dpp v108, v104 row_shl:8 row_mask:0xf bank_mask:0xf
    v_mov_b32_dpp v109, v105 row_shl:8 row_mask:0xf bank_mask:0xf
    v_mov_b32_dpp v116, v112 row_shl:8 row_mask:0xf bank_mask:0xf
    v_mov_b32_dpp v117, v113 row_shl:8 row_mask:0xf bank_mask:0xf
    v_mov_b32_dpp v110, v104 row_shl:12 row_mask:0xf bank_mask:0xf
    v_mov_b32_dpp v111, v105 row_shl:12 row_mask:0xf bank_mask:0xf
    v_mov_b32_dpp v118, v112 row_shl:12 row_mask:0xf bank_mask:0xf
    v_mov_b32_dpp v119, v113 row_shl:12 row_mask:0xf bank_mask:0xf
    s_waitcnt lgkmcnt(0)
    v_mfma_f32_16x16x32_bf16 v[44:47], v[104:107], v[64:67], 0
    v_mfma_f32_16x16x32_bf16 v[48:51], v[104:107], v[80:83], 0
    v_mfma_f32_16x16x32_bf16 v[44:47], v[108:111], v[68:71], v[44:47]
    v_mfma_f32_16x16x32_bf16 v[48:51], v[108:111], v[84:87], v[48:51]
    v_mfma_f32_16x16x32_bf16 v[44:47], v[112:115], v[72:75], v[44:47]
    v_mfma_f32_16x16x32_bf16 v[48:51], v[112:115], v[88:91], v[48:51]
    v_mfma_f32_16x16x32_bf16 v[44:47], v[116:119], v[76:79], v[44:47]
    v_mfma_f32_16x16x32_bf16 v[48:51], v[116:119], v[92:95], v[48:51]
    s_nop 6
    v_add_f32 v44, v44, v45
    v_add_f32 v46, v46, v47
    v_add_f32 v48, v48, v49
    v_add_f32 v50, v50, v51
    v_add_f32 v44, v44, v46
    v_add_f32 v48, v48, v50
    s_nop 1
    v_permlane16_swap_b32 v44, v48
    s_mov_b32 exec_hi, 0
    v_mul_f32 v44, 0x3e0293ee, v44
    v_cvt_pk_bf16_f32 v44, v44, v44
    v_perm_b32 v44, v44, s49, v62
    buffer_store_dword v44, v12, s[36:39], s58 offen sc1
    s_mov_b32 exec_hi, -1
    s_getreg_b32 s53, hwreg(HW_REG_XCC_ID, 0, 4)
    v_cmp_ne_u16 vcc, s53, v97
    v_cmp_ne_u16 s[56:57], s53, v101
    s_or_b64 vcc, vcc, s[56:57]
    s_cselect_b32 s53, 1, 0
    v_mov_b32 v14, s53
    ds_write_b32 v43, v14 offset:80
    s_waitcnt lgkmcnt(0)
Lna2_24:
    s_branch LPAGE2
    .p2align 12
LPAGE2:
    s_cmp_ge_u32 s3, 27
    s_cbranch_scc1 Lnoffn_29
    s_cmp_ge_u32 s44, 4
    s_cbranch_scc1 Lhi_30
    s_lshl3_add_u32 s53, s46, s44
    s_lshl_b32 s53, s53, 17
    s_lshl_b32 s58, s45, 8
    s_add_u32 s50, s53, s58
    s_lshl_b32 s51, s44, 12
    s_add_u32 s51, s51, 32768
    s_barrier
    s_mov_b32 m0, s51
    s_add_u32 s51, s51, 1024
    buffer_load_dwordx4 v20, s[32:35], s50 offen nt lds
    s_add_u32 s50, s50, 32768
    s_mov_b32 m0, s51
    s_add_u32 s51, s51, 1024
    buffer_load_dwordx4 v20, s[32:35], s50 offen nt lds
    s_add_u32 s50, s50, 32768
    s_mov_b32 m0, s51
    s_add_u32 s51, s51, 1024
    buffer_load_dwordx4 v20, s[32:35], s50 offen nt lds
    s_add_u32 s50, s50, 32768
    s_mov_b32 m0, s51
    s_nop 0
    buffer_load_dwordx4 v20, s[32:35], s50 offen nt lds
    s_mov_b32 s40, s22
    s_mov_b32 s41, s23
    s_mov_b32 s42, 2211840
    s_lshl2_add_u32 s53, s3, s44
    s_mul_i32 s50, s53, 20480
    s_mul_i32 s53, s46, 320
    s_add_u32 s50, s50, s53
    s_mul_i32 s51, s44, 5120
    s_add_u32 s51, s51, 86016
    s_mov_b32 m0, s51
    s_add_u32 s51, s51, 1024
    buffer_load_dwordx4 v22, s[40:43], s50 offen nt lds
    s_mov_b32 m0, s51
    s_add_u32 s51, s51, 1024
    buffer_load_dwordx4 v23, s[40:43], s50 offen nt lds
    s_mov_b32 m0, s51
    s_add_u32 s51, s51, 1024
    buffer_load_dwordx4 v24, s[40:43], s50 offen nt lds
    s_mov_b32 m0, s51
    s_add_u32 s51, s51, 1024
    buffer_load_dwordx4 v25, s[40:43], s50 offen nt lds
    s_mov_b32 m0, s51
    s_nop 0
    buffer_load_dwordx4 v26, s[40:43], s50 offen nt lds
    s_barrier
    s_branch Lf1e_31
Lhi_30:
    s_mov_b32 s40, s18
    s_mov_b32 s41, s19
    s_mov_b32 s42, 2211840
    v_lshrrev_b32 v14, 3, v1
    v_and_b32 v21, 6, v14
    v_xor_b32 v21, v21, v1
    v_and_b32 v21, 7, v21
    s_movk_i32 s53, 3456
    v_lshlrev_b32 v21, 4, v21
    v_mad_u32_u24 v21, v14, s53, v21
    s_sub_u32 s53, s44, 4
    s_lshl_b32 s51, s53, 10
    s_add_u32 s51, s51, 65536
    s_mul_i32 s58, s46, 160
    s_lshl3_add_u32 s53, s53, s58
    s_mul_i32 s50, s53, 3456
    s_lshl_b32 s53, s3, 7
    s_add_u32 s50, s50, s53
    s_barrier
    s_mov_b32 m0, s51
    s_add_u32 s51, s51, 4096
    buffer_load_dwordx4 v21, s[40:43], s50 offen nt lds
    s_add_u32 s50, s50, 110592
    s_mov_b32 m0, s51
    s_add_u32 s51, s51, 4096
    buffer_load_dwordx4 v21, s[40:43], s50 offen nt lds
    s_add_u32 s50, s50, 110592
    s_mov_b32 m0, s51
    s_add_u32 s51, s51, 4096
    buffer_load_dwordx4 v21, s[40:43], s50 offen nt lds
    s_add_u32 s50, s50, 110592
    s_mov_b32 m0, s51
    s_add_u32 s51, s51, 4096
    buffer_load_dwordx4 v21, s[40:43], s50 offen nt lds
    s_add_u32 s50, s50, 110592
    s_mov_b32 m0, s51
    s_nop 0
    buffer_load_dwordx4 v21, s[40:43], s50 offen nt lds
    s_lshl3_add_u32 s53, s46, s44
    s_lshl_b32 s53, s53, 17
    s_lshl_b32 s58, s45, 8
    s_add_u32 s50, s53, s58
    s_lshl_b32 s51, s44, 12
    s_add_u32 s51, s51, 32768
    s_mov_b32 m0, s51
    s_add_u32 s51, s51, 1024
    buffer_load_dwordx4 v20, s[32:35], s50 offen nt lds
    s_add_u32 s50, s50, 32768
    s_mov_b32 m0, s51
    s_add_u32 s51, s51, 1024
    buffer_load_dwordx4 v20, s[32:35], s50 offen nt lds
    s_add_u32 s50, s50, 32768
    s_mov_b32 m0, s51
    s_add_u32 s51, s51, 1024
    buffer_load_dwordx4 v20, s[32:35], s50 offen nt lds
    s_add_u32 s50, s50, 32768
    s_mov_b32 m0, s51
    s_nop 0
    buffer_load_dwordx4 v20, s[32:35], s50 offen nt lds
    ds_read2_b64 v[128:131], v31 offset0:0 offset1:4
    ds_read2_b64 v[132:135], v31 offset0:8 offset1:12
    ds_read2_b64 v[136:139], v31 offset0:16 offset1:20
    ds_read2_b64 v[140:143], v31 offset0:24 offset1:28
    ds_read2_b64 v[144:147], v31 offset0:32 offset1:36
    s_lshl_b32 s50, s45, 11
    s_lshl4_add_u32 s50, s46, s50
    s_lshl_b32 s53, s44, 6
    s_add_u32 s50, s50, s53
    s_add_u32 s50, s50, 392960
    s_lshl2_add_u32 s58, s45, s46
    s_lshl2_add_u32 s58, s58, s44
    s_lshl_b32 s58, s58, 7
    s_add_u32 s58, s58, 4783616
    s_waitcnt vmcnt(4)
    s_barrier
    ds_read_b64_tr_b16 v[64:65], v28 offset:0
    ds_read_b64_tr_b16 v[66:67], v28 offset:2048
    ds_read_b64_tr_b16 v[68:69], v28 offset:4096
    ds_read_b64_tr_b16 v[70:71], v28 offset:6144
    ds_read_b64_tr_b16 v[72:73], v28 offset:8192
    ds_read_b64_tr_b16 v[74:75], v28 offset:10240
    ds_read_b64_tr_b16 v[76:77], v28 offset:12288
    ds_read_b64_tr_b16 v[78:79], v28 offset:14336
    ds_read_b64_tr_b16 v[80:81], v28 offset:16384
    ds_read_b64_tr_b16 v[82:83], v28 offset:18432
    s_waitcnt lgkmcnt(0)
    v_mfma_f32_16x16x32_bf16 v[44:47], v[128:131], v[64:67], 0
    v_mfma_f32_16x16x32_bf16 v[44:47], v[132:135], v[68:71], v[44:47]
    v_mfma_f32_16x16x32_bf16 v[44:47], v[136:139], v[72:75], v[44:47]
    v_mfma_f32_16x16x32_bf16 v[44:47], v[140:143], v[76:79], v[44:47]
    v_mfma_f32_16x16x32_bf16 v[44:47], v[144:147], v[80:83], v[44:47]
    s_mov_b64 exec, 0xffff
    s_nop 6
    v_perm_b32 v44, v44, s49, v61
    buffer_store_dword v44, v32, s[36:39], s50 offen
    buffer_store_dword v44, v12, s[36:39], s58 offen sc1
    s_mov_b64 exec, -1
    s_branch Lf1e_31
Lnoffn_29:
    s_lshl3_add_u32 s53, s46, s44
    s_lshl_b32 s53, s53, 17
    s_lshl_b32 s58, s45, 8
    s_add_u32 s50, s53, s58
    s_lshl_b32 s51, s44, 12
    s_add_u32 s51, s51, 32768
    s_barrier
    s_mov_b32 m0, s51
    s_add_u32 s51, s51, 1024
    buffer_load_dwordx4 v20, s[32:35], s50 offen nt lds
    s_add_u32 s50, s50, 32768
    s_mov_b32 m0, s51
    s_add_u32 s51, s51, 1024
    buffer_load_dwordx4 v20, s[32:35], s50 offen nt lds
    s_add_u32 s50, s50, 32768
    s_mov_b32 m0, s51
    s_add_u32 s51, s51, 1024
    buffer_load_dwordx4 v20, s[32:35], s50 offen nt lds
    s_add_u32 s50, s50, 32768
    s_mov_b32 m0, s51
    s_nop 0
    buffer_load_dwordx4 v20, s[32:35], s50 offen nt lds
Lf1e_31:
    s_add_u32 s97, s97, 1024
    s_add_u32 s99, s99, 262144
    s_lshl3_add_u32 s53, s45, s44
    s_lshl_b32 s53, s53, 6
    s_add_u32 s53, s53, 720896
    s_add_u32 s20, s30, s53
    s_addc_u32 s21, s31, 0
    s_mov_b32 s52, 0
    s_mov_b32 s56, 0x00030003
    s_mov_b32 s57, 0x00030003
    s_mov_b64 s[54:55], -1
    s_waitcnt lgkmcnt(0)
Lh3s_32:
    s_load_dwordx16 s[4:19], s[20:21], 0 glc
    s_add_u32 s52, s52, 1
    s_cmp_gt_u32 s52, 400000
    s_cbranch_scc1 LEXIT
    s_waitcnt lgkmcnt(0)
    s_xor_b32 s53, s5, s49
    s_xor_b32 s7, s7, s49
    s_or_b32 s53, s53, s7
    s_xor_b32 s9, s9, s49
    s_or_b32 s53, s53, s9
    s_xor_b32 s11, s11, s49
    s_or_b32 s53, s53, s11
    s_xor_b32 s13, s13, s49
    s_or_b32 s53, s53, s13
    s_xor_b32 s15, s15, s49
    s_or_b32 s53, s53, s15
    s_xor_b32 s17, s17, s49
    s_or_b32 s53, s53, s17
    s_xor_b32 s19, s19, s49
    s_or_b32 s53, s53, s19
    s_cbranch_scc1 Lh3s_32
    buffer_load_dwordx4 v[84:87], v42, s[36:39], s99 offen sc1
    s_mov_b64 exec, s[56:57]
    buffer_load_dwordx2 v[74:75], v13, s[36:39], s97 offen sc1
    s_mov_b64 exec, s[54:55]
    buffer_load_dwordx4 v[64:67], v60, s[36:39], s62 offen sc1
    buffer_load_dwordx4 v[68:71], v60, s[36:39], s63 offen sc1
    s_mov_b32 exec_lo, 0xffff
    s_mov_b32 exec_hi, 0x0
    v_mov_b32 v16, s4
    v_mov_b32 v17, s12
    s_mov_b32 exec_lo, 0xffff0000
    s_mov_b32 exec_hi, 0x0
    v_mov_b32 v16, s6
    v_mov_b32 v17, s14
    s_mov_b32 exec_lo, 0x0
    s_mov_b32 exec_hi, 0xffff
    v_mov_b32 v16, s8
    v_mov_b32 v17, s16
    s_mov_b32 exec_lo, 0x0
    s_mov_b32 exec_hi, 0xffff0000
    v_mov_b32 v16, s10
    v_mov_b32 v17, s18
    s_mov_b64 exec, -1
    s_lshl_b32 s53, s44, 2
    v_add_u32 v19, s53, v43
    v_max_f32 v14, v16, v17
    v_mov_b32 v15, v14
    s_nop 1
    v_permlane32_swap_b32 v14, v15
    v_max_f32 v14, v14, v15
    v_mov_b32 v15, v14
    s_nop 1
    v_permlane16_swap_b32 v14, v15
    v_max_f32 v14, v14, v15
    ds_write_b32 v19, v14
    s_lshl_b32 s50, s45, 11
    s_lshl4_add_u32 s50, s46, s50
    s_lshr_b32 s53, s44, 2
    s_lshl_b32 s53, s53, 10
    s_add_u32 s50, s50, s53
    s_and_b32 s53, s44, 3
    s_lshl_b32 s53, s53, 6
    s_add_u32 s50, s50, s53
    s_add_u32 s50, s50, 262144
    s_lshl2_add_u32 s58, s45, s46
    s_lshl3_add_u32 s58, s58, s44
    s_lshl_b32 s58, s58, 7
    s_add_u32 s58, s58, 4653056
    s_waitcnt vmcnt(4) lgkmcnt(0)
    s_barrier
    ds_read_b128 v[96:99], v43
    ds_read_b128 v[100:103], v43 offset:16
    ds_read_b32 v104, v43 offset:80
    s_waitcnt lgkmcnt(0)
    v_readfirstlane_b32 s101, v104
    ds_read_b64_tr_b16 v[160:161], v27 offset:0
    ds_read_b64_tr_b16 v[162:163], v27 offset:16384
    ds_read_b64_tr_b16 v[164:165], v27 offset:1024
    ds_read_b64_tr_b16 v[166:167], v27 offset:17408
    ds_read_b64_tr_b16 v[168:169], v27 offset:2048
    ds_read_b64_tr_b16 v[170:171], v27 offset:18432
    ds_read_b64_tr_b16 v[172:173], v27 offset:3072
    ds_read_b64_tr_b16 v[174:175], v27 offset:19456
    s_cmp_ge_u32 s3, 27
    s_cbranch_scc1 Lnf2_33
    s_cmp_ge_u32 s44, 5
    s_cbranch_scc1 Lnf2_33
    ds_read_b64_tr_b16 v[128:129], v29 offset:0
    ds_read_b64_tr_b16 v[130:131], v29 offset:5120
    ds_read_b64_tr_b16 v[132:133], v29 offset:10240
    ds_read_b64_tr_b16 v[134:135], v29 offset:15360
    ds_read_b64_tr_b16 v[136:137], v30 offset:0
    ds_read_b64_tr_b16 v[138:139], v30 offset:5120
    ds_read_b64_tr_b16 v[140:141], v30 offset:10240
    ds_read_b64_tr_b16 v[142:143], v30 offset:15360
Lnf2_33:
    v_max3_f32 v14, v96, v97, v98
    v_max3_f32 v15, v99, v100, v101
    v_max3_f32 v14, v14, v102, v103
    v_max_f32 v14, v14, v15
    v_sub_f32 v16, v16, v14
    v_sub_f32 v17, v17, v14
    v_exp_f32 v16, v16
    v_exp_f32 v17, v17
    s_branch Lh3c_35
Lh3_34:
    s_mov_b64 exec, s[56:57]
    buffer_load_dwordx2 v[74:75], v13, s[36:39], s97 offen sc1
    s_mov_b64 exec, s[54:55]
    buffer_load_dwordx4 v[64:67], v60, s[36:39], s62 offen sc1
    buffer_load_dwordx4 v[68:71], v60, s[36:39], s63 offen sc1
    s_add_u32 s52, s52, 1
    s_cmp_gt_u32 s52, 400000
    s_cbranch_scc1 LEXIT
Lh3c_35:
    s_mov_b64 exec, s[54:55]
    s_waitcnt vmcnt(1)
    v_cmp_eq_u32 vcc, -1, v67
    v_lshlrev_b32 v96, 16, v64
    v_and_b32 v97, 0xffff0000, v64
    v_lshlrev_b32 v98, 16, v65
    v_and_b32 v99, 0xffff0000, v65
    v_lshlrev_b32 v100, 16, v66
    v_and_b32 v101, 0xffff0000, v66
    v_lshlrev_b32 v102, 16, v67
    v_and_b32 v103, 0xffff0000, v67
    v_mul_f32 v96, v96, v16
    v_mul_f32 v97, v97, v16
    v_mul_f32 v98, v98, v16
    v_mul_f32 v99, v99, v16
    v_mul_f32 v100, v100, v16
    v_mul_f32 v101, v101, v16
    v_mul_f32 v102, v102, v16
    v_mul_f32 v103, v103, v16
    s_waitcnt vmcnt(0)
    v_cmp_eq_u32 s[54:55], -1, v71
    s_mov_b64 exec, s[56:57]
    s_or_b64 s[54:55], s[54:55], vcc
    v_cmp_ne_u32 s[56:57], v75, v6
    s_or_b64 vcc, s[54:55], s[56:57]
    s_cbranch_scc1 Lh3_34
    s_mov_b64 exec, -1
    v_mov_b32_dpp v14, v74 row_newbcast:0 row_mask:0xf bank_mask:0xf
    v_mov_b32_dpp v15, v74 row_newbcast:1 row_mask:0xf bank_mask:0xf
    v_mul_f32 v18, v16, v14
    v_fmac_f32 v18, v17, v15
    v_lshlrev_b32 v104, 16, v68
    v_and_b32 v105, 0xffff0000, v68
    v_lshlrev_b32 v106, 16, v69
    v_and_b32 v107, 0xffff0000, v69
    v_lshlrev_b32 v108, 16, v70
    v_and_b32 v109, 0xffff0000, v70
    v_lshlrev_b32 v110, 16, v71
    v_and_b32 v111, 0xffff0000, v71
    v_fmac_f32 v96, v104, v17
    v_fmac_f32 v100, v108, v17
    v_fmac_f32 v97, v105, v17
    v_fmac_f32 v101, v109, v17
    v_fmac_f32 v98, v106, v17
    v_fmac_f32 v102, v110, v17
    v_fmac_f32 v99, v107, v17
    v_fmac_f32 v103, v111, v17
    v_mov_b32 v14, v18
    v_permlane32_swap_b32 v96, v100
    v_permlane32_swap_b32 v97, v101
    v_permlane32_swap_b32 v98, v102
    v_permlane32_swap_b32 v99, v103
    v_permlane32_swap_b32 v18, v14
    v_add_f32 v96, v96, v100
    v_add_f32 v98, v98, v102
    v_add_f32 v97, v97, v101
    v_add_f32 v99, v99, v103
    v_add_f32 v18, v18, v14
    v_mov_b32 v14, v18
    v_permlane16_swap_b32 v96, v98
    v_permlane16_swap_b32 v97, v99
    v_permlane16_swap_b32 v18, v14
    v_add_f32 v96, v96, v98
    v_add_f32 v97, v97, v99
    v_add_f32 v18, v18, v14
    v_cvt_pk_bf16_f32 v96, v96, v97
    ds_write_b32 v40, v96
    ds_write_b32 v19, v18 offset:32
    s_waitcnt lgkmcnt(0)
    s_barrier
    ds_read_b128 v[104:107], v41 offset:0
    ds_read_b128 v[108:111], v41 offset:64
    ds_read_b128 v[112:115], v41 offset:128
    ds_read_b128 v[116:119], v41 offset:192
    ds_read_b128 v[64:67], v43 offset:32
    ds_read_b128 v[68:71], v43 offset:48
    s_waitcnt lgkmcnt(5)
    v_mfma_f32_16x16x32_bf16 v[44:47], v[104:107], v[160:163], 0
    s_waitcnt lgkmcnt(4)
    v_mfma_f32_16x16x32_bf16 v[44:47], v[108:111], v[164:167], v[44:47]
    s_waitcnt lgkmcnt(3)
    v_mfma_f32_16x16x32_bf16 v[44:47], v[112:115], v[168:171], v[44:47]
    s_waitcnt lgkmcnt(2)
    v_mfma_f32_16x16x32_bf16 v[44:47], v[116:119], v[172:175], v[44:47]
    s_waitcnt lgkmcnt(0)
    v_add_f32 v64, v64, v65
    v_add_f32 v66, v66, v67
    v_add_f32 v68, v68, v69
    v_add_f32 v70, v70, v71
    v_add_f32 v64, v64, v66
    v_add_f32 v68, v68, v70
    v_add_f32 v64, v64, v68
    v_add_f32 v44, v44, v45
    v_rcp_f32 v64, v64
    v_add_f32 v46, v46, v47
    v_add_f32 v44, v44, v46
    v_mov_b32 v45, v44
    s_nop 1
    v_permlane16_swap_b32 v44, v45
    s_mov_b64 exec, 0xffff
    v_add_f32 v44, v44, v45
    v_mul_f32 v44, v44, v64
    v_cvt_pk_bf16_f32 v44, v44, v44
    v_perm_b32 v44, v44, s49, v62
    buffer_store_dword v44, v32, s[36:39], s50 offen
    s_mov_b64 exec, -1
    v_mov_b32 v33, v44
    s_mov_b32 s97, s58
    s_mov_b32 s63, s58
    s_cmp_ge_u32 s44, 5
    s_cselect_b32 s53, 27, s3
    s_cmp_lt_u32 s53, 27
    s_cbranch_scc1 Ldof2_36
    s_waitcnt vmcnt(0)
    s_cmp_lg_u32 s101, 0
    s_cselect_b64 exec, 0xffff, 0
    s_cbranch_scc0 Lny_37
    buffer_store_dword v33, v12, s[36:39], s97 offen sc1
Lny_37:
    s_mov_b64 exec, -1
    s_cmp_ge_u32 s3, 27
    s_cbranch_scc1 LFINAL
    s_branch LEXIT
Ldof2_36:
    v_perm_b32 v14, v85, v84, s59
    v_perm_b32 v15, v87, v86, s59
    v_lshl_or_b32 v14, v15, 16, v14
    v_cmp_ne_u32 vcc, v14, v6
    s_cbranch_vccz Lhok_38
    s_cmp_lg_u32 s101, 0
    s_cselect_b64 exec, 0xffff, 0
    s_cbranch_scc0 Lny_39
    buffer_store_dword v33, v12, s[36:39], s97 offen sc1
Lny_39:
    s_mov_b64 exec, -1
    s_mov_b32 s52, 0
Lpd_40:
    buffer_load_dwordx4 v[84:87], v42, s[36:39], s99 offen offset:0 sc1
    s_add_u32 s52, s52, 1
    s_cmp_gt_u32 s52, 64
    s_cbranch_scc1 Lslow_41
    s_waitcnt vmcnt(0)
    v_perm_b32 v14, v85, v84, s59
    v_perm_b32 v15, v87, v86, s59
    v_lshl_or_b32 v14, v15, 16, v14
    v_cmp_ne_u32 vcc, v14, v6
    s_cbranch_vccnz Lpd_40
Lpdd_42:
Lhok_38:
    v_and_b32 v84, s96, v84
    v_and_b32 v85, s96, v85
    v_and_b32 v86, s96, v86
    v_and_b32 v87, s96, v87
    v_add_f32_dpp v84, v84, v84 quad_perm:[1,0,3,2] row_mask:0xf bank_mask:0xf
    v_add_f32_dpp v85, v85, v85 quad_perm:[1,0,3,2] row_mask:0xf bank_mask:0xf
    v_add_f32_dpp v86, v86, v86 quad_perm:[1,0,3,2] row_mask:0xf bank_mask:0xf
    v_add_f32_dpp v87, v87, v87 quad_perm:[1,0,3,2] row_mask:0xf bank_mask:0xf
    v_add_f32_dpp v84, v84, v84 quad_perm:[2,3,0,1] row_mask:0xf bank_mask:0xf
    v_add_f32_dpp v85, v85, v85 quad_perm:[2,3,0,1] row_mask:0xf bank_mask:0xf
    v_add_f32_dpp v86, v86, v86 quad_perm:[2,3,0,1] row_mask:0xf bank_mask:0xf
    v_add_f32_dpp v87, v87, v87 quad_perm:[2,3,0,1] row_mask:0xf bank_mask:0xf
    v_cvt_pk_bf16_f32 v14, v84, v85
    v_cvt_pk_bf16_f32 v15, v86, v87
    v_lshlrev_b32 v84, 16, v14
    v_and_b32 v85, 0xffff0000, v14
    v_lshlrev_b32 v16, 16, v34
    v_and_b32 v17, 0xffff0000, v34
    v_add_f32 v84, v84, v16
    v_add_f32 v85, v85, v17
    v_max_f32 v84, 0, v84
    v_max_f32 v85, 0, v85
    v_cvt_pk_bf16_f32 v14, v84, v85
    v_lshlrev_b32 v84, 16, v14
    v_and_b32 v85, 0xffff0000, v14
    v_mul_f32 v84, v84, v84
    v_mul_f32 v85, v85, v85
    v_cvt_pk_bf16_f32 v104, v84, v85
    v_lshlrev_b32 v86, 16, v15
    v_and_b32 v87, 0xffff0000, v15
    v_lshlrev_b32 v16, 16, v35
    v_and_b32 v17, 0xffff0000, v35
    v_add_f32 v86, v86, v16
    v_add_f32 v87, v87, v17
    v_max_f32 v86, 0, v86
    v_max_f32 v87, 0, v87
    v_cvt_pk_bf16_f32 v15, v86, v87
    v_lshlrev_b32 v86, 16, v15
    v_and_b32 v87, 0xffff0000, v15
    v_mul_f32 v86, v86, v86
    v_mul_f32 v87, v87, v87
    v_cvt_pk_bf16_f32 v105, v86, v87
    v_mov_b32_dpp v106, v104 row_shl:4 row_mask:0xf bank_mask:0xf
    s_nop 0
    v_mov_b32_dpp v107, v105 row_shl:4 row_mask:0xf bank_mask:0xf
    v_mov_b32_dpp v108, v104 row_shl:8 row_mask:0xf bank_mask:0xf
    v_mov_b32_dpp v109, v105 row_shl:8 row_mask:0xf bank_mask:0xf
    v_mov_b32_dpp v110, v104 row_shl:12 row_mask:0xf bank_mask:0xf
    v_mov_b32_dpp v111, v105 row_shl:12 row_mask:0xf bank_mask:0xf
    s_add_u32 s58, s3, 32
    s_mul_i32 s62, s58, 2560
    s_mul_i32 s53, s46, 640
    s_add_u32 s62, s62, s53
    s_lshl_b32 s53, s44, 7
    s_add_u32 s62, s62, s53
    s_add_u32 s62, s62, 524288
    v_mfma_f32_16x16x32_bf16 v[44:47], v[104:107], v[128:131], 0
    v_mfma_f32_16x16x32_bf16 v[48:51], v[104:107], v[136:139], 0
    v_mfma_f32_16x16x32_bf16 v[44:47], v[108:111], v[132:135], v[44:47]
    v_mfma_f32_16x16x32_bf16 v[48:51], v[108:111], v[140:143], v[48:51]
    s_nop 7
    v_permlane16_swap_b32 v44, v48
    s_mov_b32 exec_hi, 0
    v_perm_b32 v44, v44, s49, v61
    buffer_store_dword v44, v12, s[36:39], s62 offen sc1
    s_cmp_lg_u32 s101, 0
    s_cselect_b64 exec, 0xffff, 0
    s_cbranch_scc0 Lny_44
    buffer_store_dword v33, v12, s[36:39], s97 offen sc1
Lny_44:
    s_mov_b64 exec, -1
    s_branch LEXIT
LFINAL:
    s_cmp_ge_u32 s44, 2
    s_cbranch_scc1 LEXIT
    s_mov_b32 s32, s26
    s_mov_b32 s33, s27
    s_mov_b32 s34, 1280
    s_movk_i32 s53, 2560
    v_lshrrev_b32 v18, 2, v1
    v_mul_u32_u24 v18, s53, v18
    v_lshl_add_u32 v18, v5, 4, v18
    s_lshl_b32 s99, s98, 6
    s_add_u32 s99, s99, 524288
    v_lshlrev_b32 v36, 16, v36
    v_lshlrev_b32 v37, 16, v37
    s_add_u32 s53, s99, 40960
    s_add_u32 s58, s99, 81920
    s_add_u32 s97, s99, 122880
    s_mov_b32 s52, 0
    s_mov_b64 s[54:55], -1
    s_mov_b64 s[56:57], -1
    s_mov_b64 s[16:17], -1
    s_mov_b32 s10, -1
    s_mov_b32 s11, 0xfff
    v_mov_b32 v116, 0
    v_mov_b32 v117, 0
    v_mov_b32 v118, 0
    v_mov_b32 v119, 0
    s_mov_b64 exec, 0xffff
    buffer_store_dword v33, v12, s[36:39], s63 offen sc1
    s_mov_b64 exec, -1
    s_waitcnt vmcnt(0)
Lfino_45:
    s_mov_b64 exec, s[16:17]
    buffer_load_dwordx4 v[112:115], v18, s[36:39], s58 offen sc1
    s_mov_b64 exec, s[10:11]
    buffer_load_dwordx4 v[116:119], v18, s[36:39], s97 offen sc1
    s_add_u32 s52, s52, 1
    s_cmp_gt_u32 s52, 400000
    s_cbranch_scc1 LEXIT
    s_mov_b64 exec, s[16:17]
    s_waitcnt vmcnt(1)
    v_perm_b32 v14, v113, v112, s59
    v_perm_b32 v15, v115, v114, s59
    v_lshl_or_b32 v14, v15, 16, v14
    v_cmp_ne_u32 s[16:17], v14, v6
    s_mov_b64 exec, s[10:11]
    s_waitcnt vmcnt(0)
    v_perm_b32 v14, v117, v116, s59
    v_perm_b32 v15, v119, v118, s59
    v_lshl_or_b32 v14, v15, 16, v14
    v_cmp_ne_u32 s[10:11], v14, v6
    s_or_b64 vcc, s[16:17], s[10:11]
    s_cbranch_scc1 Lfino_45
Lod_46:
    s_mov_b64 exec, s[54:55]
    buffer_load_dwordx4 v[96:99], v18, s[36:39], s99 offen sc1
    s_mov_b64 exec, s[56:57]
    buffer_load_dwordx4 v[100:103], v18, s[36:39], s53 offen sc1
    s_mov_b64 exec, -1
    v_and_b32 v112, s96, v112
    v_and_b32 v113, s96, v113
    v_and_b32 v114, s96, v114
    v_and_b32 v115, s96, v115
    v_and_b32 v116, s96, v116
    v_and_b32 v117, s96, v117
    v_and_b32 v118, s96, v118
    v_and_b32 v119, s96, v119
    v_add_f32 v112, v112, v116
    v_add_f32 v114, v114, v118
    v_add_f32 v113, v113, v117
    v_add_f32 v115, v115, v119
    v_permlane32_swap_b32 v112, v114
    s_nop 0
    v_permlane32_swap_b32 v113, v115
    v_add_f32 v112, v112, v114
    v_add_f32 v113, v113, v115
    s_nop 1
    v_permlane16_swap_b32 v112, v113
    v_add_f32 v112, v112, v113
    s_nop 1
    v_add_f32_dpp v112, v112, v112 row_ror:4 row_mask:0xf bank_mask:0xf
    s_nop 1
    v_add_f32_dpp v112, v112, v112 row_ror:8 row_mask:0xf bank_mask:0xf
    v_cvt_pk_bf16_f32 v112, v112, v112
    v_lshlrev_b32 v112, 16, v112
    v_add_f32 v112, v112, v37
    v_cvt_pk_bf16_f32 v112, v112, v112
    v_lshlrev_b32 v112, 16, v112
    v_mul_f32 v113, 0xbfb8aa3b, v112
    v_exp_f32 v113, v113
    s_nop 0
    v_add_f32 v113, 1.0, v113
    v_rcp_f32 v113, v113
    s_nop 0
    v_mul_f32 v112, v112, v113
    v_cvt_pk_bf16_f32 v112, v112, v112
    v_lshlrev_b32 v19, 16, v112
    s_branch Lfinc_48
Lfin_47:
    s_mov_b64 exec, s[54:55]
    buffer_load_dwordx4 v[96:99], v18, s[36:39], s99 offen sc1
    s_mov_b64 exec, s[56:57]
    buffer_load_dwordx4 v[100:103], v18, s[36:39], s53 offen sc1
    s_add_u32 s52, s52, 1
    s_cmp_gt_u32 s52, 400000
    s_cbranch_scc1 LEXIT
Lfinc_48:
    s_mov_b64 exec, s[54:55]
    s_waitcnt vmcnt(1)
    v_perm_b32 v14, v97, v96, s59
    v_perm_b32 v15, v99, v98, s59
    v_lshl_or_b32 v14, v15, 16, v14
    v_cmp_ne_u32 s[54:55], v14, v6
    s_mov_b64 exec, s[56:57]
    s_waitcnt vmcnt(0)
    v_perm_b32 v14, v101, v100, s59
    v_perm_b32 v15, v103, v102, s59
    v_lshl_or_b32 v14, v15, 16, v14
    v_cmp_ne_u32 s[56:57], v14, v6
    s_or_b64 vcc, s[54:55], s[56:57]
    s_cbranch_scc1 Lfin_47
    s_mov_b64 exec, -1
    v_and_b32 v96, s96, v96
    v_and_b32 v97, s96, v97
    v_and_b32 v98, s96, v98
    v_and_b32 v99, s96, v99
    v_and_b32 v100, s96, v100
    v_and_b32 v101, s96, v101
    v_and_b32 v102, s96, v102
    v_and_b32 v103, s96, v103
    v_add_f32 v96, v96, v100
    v_add_f32 v98, v98, v102
    v_add_f32 v97, v97, v101
    v_add_f32 v99, v99, v103
    v_permlane32_swap_b32 v96, v98
    s_nop 0
    v_permlane32_swap_b32 v97, v99
    v_add_f32 v96, v96, v98
    v_add_f32 v97, v97, v99
    s_nop 1
    v_permlane16_swap_b32 v96, v97
    v_add_f32 v96, v96, v97
    s_nop 1
    v_add_f32_dpp v96, v96, v96 row_ror:4 row_mask:0xf bank_mask:0xf
    s_nop 1
    v_add_f32_dpp v96, v96, v96 row_ror:8 row_mask:0xf bank_mask:0xf
    v_cvt_pk_bf16_f32 v96, v96, v96
    v_lshlrev_b32 v96, 16, v96
    v_mul_f32 v96, v96, v19
    v_cvt_pk_bf16_f32 v96, v96, v96
    v_lshlrev_b32 v96, 16, v96
    v_add_f32 v96, v96, v36
    v_cvt_pk_bf16_f32 v96, v96, v96
    s_lshl_b32 s50, s98, 5
    s_mov_b32 exec_lo, 0x000f000f
    s_mov_b32 exec_hi, 0x000f000f
    buffer_store_short v96, v38, s[32:35], s50 offen
    s_cmp_lg_u32 s98, 0
    s_cbranch_scc1 LEXIT
    s_mov_b64 exec, 1
    buffer_store_dword v6, v38, s[36:39], 0 offen
LEXIT:
LEND:
    s_endpgm
KEND:
.section .rodata,"a"
.p2align 6
.amdhsa_kernel recurrent_scan__compressed_kv_cla__dense_activation_squared_relu__decode_kernel
  .amdhsa_next_free_vgpr 256
  .amdhsa_next_free_sgpr 102
  .amdhsa_accum_offset 256
  .amdhsa_group_segment_fixed_size 0
  .amdhsa_kernarg_size 112
  .amdhsa_user_sgpr_count 2
  .amdhsa_user_sgpr_kernarg_segment_ptr 1
  .amdhsa_system_sgpr_workgroup_id_x 1
.end_amdhsa_kernel
```
